```python
import torch

def _softmax(x, axis=-1):
    return torch.softmax(x, dim=axis)
def _gelu(x):
    return torch.nn.functional.gelu(x, approximate="tanh")
def _silu(x):
    return torch.nn.functional.silu(x)
def _sigmoid(x):
    return torch.sigmoid(x)
def _layernorm(x, axis=-1, eps=1e-5):
    m = x.mean(dim=axis, keepdim=True)
    v = x.var(dim=axis, keepdim=True, unbiased=False)
    return (x - m) / torch.sqrt(v + eps)
def _scatter_add(tgt, idx, src, axis=0):
    return tgt.clone().index_add_(axis, idx, src)
def _segment_sum(src, seg, n):
    out = torch.zeros((n,) + src.shape[1:], dtype=src.dtype)
    return out.index_add_(0, seg, src)
def _pad(x, pw):
    flat = tuple(v for pair in reversed(pw) for v in pair)
    return torch.nn.functional.pad(x, flat)

kernel_name = 'standalone__hybrid_graph_tf_nagphormer__graph'

def setup_inputs():

    _w = (lambda a: (lambda t: t.to(torch.bfloat16) if t.is_floating_point() else t)(torch.as_tensor(a)))
    N, deg, D = 12500, 32, 128
    E = N * deg
    src = (lambda lo, hi, *s: torch.randint(lo, hi, s))(0, N, E).to(torch.int64)
    dst = (lambda lo, hi, *s: torch.randint(lo, hi, s))(0, N, E).to(torch.int64)
    deg_cnt = torch.bincount(dst, minlength=N).to(float) + 1.0
    sc = 1.0 / D ** 0.5
    return {
        "x": _w((lambda *s: torch.randn(*s, dtype=torch.bfloat16) * 0.1)(N, D)),
        "src": _w(src),
        "dst": _w(dst),
        "deg_inv_sqrt": _w(1.0 / (lambda _x: torch.sqrt(torch.as_tensor(_x)))(deg_cnt)),
        "wq": _w((lambda *s: torch.randn(*s, dtype=torch.bfloat16) * 1.6)(D, D) * sc),
        "wk": _w((lambda *s: torch.randn(*s, dtype=torch.bfloat16) * 1.6)(D, D) * sc),
        "wv": _w((lambda *s: torch.randn(*s, dtype=torch.bfloat16) * 0.1)(D, D) * sc),
        "wo": _w((lambda *s: torch.randn(*s, dtype=torch.bfloat16) * 0.1)(D, D) * sc),
        "w_r": _w((lambda *s: torch.randn(*s, dtype=torch.bfloat16) * 0.1)(D)),
    }

def reference(x, src, dst, deg_inv_sqrt, wq, wk, wv, wo, w_r):
    N, D = x.shape[0], x.shape[1]
    K = 7
    h = x
    toks = [x]
    for _ in range(K):
        msg = h[src] * deg_inv_sqrt[src, None] * deg_inv_sqrt[dst, None]
        h = _segment_sum(msg, dst, N)
        toks.append(h)
    tok = torch.stack(toks, axis=1)
    t = _layernorm(tok, axis=-1)
    q   = torch.einsum('nkd,de->nke', t, wq)
    key = torch.einsum('nkd,de->nke', t, wk)
    v   = torch.einsum('nkd,de->nke', t, wv)
    scale = 1.0 / (D ** 0.5)
    attn = _softmax(torch.einsum('nkd,nld->nkl', q, key) * scale, axis=-1)
    o = torch.einsum('nkl,nld->nkd', attn, v)
    o = tok + torch.einsum('nkd,de->nke', o, wo)
    r = _layernorm(o, axis=-1)
    alpha = _softmax(torch.einsum('nkd,d->nk', r, w_r), axis=-1)
    return torch.einsum('nk,nkd->nd', alpha, o)
```

```asm
; @launch kernel=k1_kernel grid=(250,1,1) block=(512,1,1) lds=8448
; @launch kernel=k2_kernel grid=(248,1,1) block=(1024,1,1) lds=70656
; @launch kernel=h_kernel grid=(256,1,1) block=(1024,1,1) lds=116736
; @launch kernel=c_kernel grid=(256,1,1) block=(1024,1,1) lds=151616
.amdgcn_target "amdgcn-amd-amdhsa--gfx950"
.text
.globl k1_kernel
.p2align 8
.type k1_kernel,@function
k1_kernel:
  s_cmp_ge_u32 s2, 250
  s_cbranch_scc1 k1_end
  s_load_dwordx4 s[8:11], s[0:1], 0
  s_load_dwordx2 s[12:13], s[0:1], 16
  s_load_dwordx2 s[26:27], s[0:1], 88
  s_sub_u32 s3, s2, 0
  s_mul_i32 s4, s3, 6400
  v_lshlrev_b32 v1, 4, v0
  v_add_u32 v2, s4, v1
  v_lshlrev_b32 v3, 2, v0
  v_mov_b32 v4, 0
  v_mov_b32 v5, 1
  v_mov_b32 v7, 0x8000
  v_cmp_gt_u32 vcc, 400, v0
  s_mov_b64 s[28:29], vcc
  v_cmp_gt_u32 vcc, 256, v0
  s_and_saveexec_b64 s[30:31], vcc
  s_cbranch_execz k1s_a
  ds_write_b32 v3, v4 offset:0
k1s_a:
  s_mov_b64 exec, s[28:29]
  s_waitcnt lgkmcnt(0)
  s_cbranch_execz k1s_b
  global_load_dwordx4 v[8:11], v2, s[10:11]
  global_load_dwordx4 v[12:15], v2, s[12:13]
k1s_b:
  s_barrier
  s_cbranch_execz k1s_c
  s_waitcnt vmcnt(0)
  v_lshrrev_b32 v16, 4, v12
  v_and_b32 v16, 0x3fc, v16
  ds_add_rtn_u32 v20, v16, v5 offset:0
  v_sub_u32 v24, v8, v12
  v_and_b32 v24, 31, v24
  v_lshrrev_b32 v26, 5, v8
  v_or_b32 v26, 1, v26
  v_mul_u32_u24 v26, 1338, v26
  v_cmp_le_u32 s[14:15], 8, v24
  v_cmp_gt_u16 vcc, 0xa740, v26
  v_and_b32 v25, 63, v12
  s_nop 0
  v_cndmask_b32 v26, v7, v4, vcc
  v_or_b32 v8, v8, v26
  s_or_b64 vcc, vcc, s[14:15]
  v_cndmask_b32 v26, 0, 64, vcc
  v_or_b32 v25, v25, v26
  v_lshl_or_b32 v24, v25, 6, v24
  v_and_b32 v25, 32, v12
  v_lshl_or_b32 v24, v25, 10, v24
  v_lshl_or_b32 v8, v8, 16, v24
  v_lshrrev_b32 v17, 4, v13
  v_and_b32 v17, 0x3fc, v17
  ds_add_rtn_u32 v21, v17, v5 offset:0
  v_sub_u32 v24, v9, v13
  v_and_b32 v24, 31, v24
  v_lshrrev_b32 v26, 5, v9
  v_or_b32 v26, 1, v26
  v_mul_u32_u24 v26, 1338, v26
  v_cmp_le_u32 s[14:15], 8, v24
  v_cmp_gt_u16 vcc, 0xa740, v26
  v_and_b32 v25, 63, v13
  s_nop 0
  v_cndmask_b32 v26, v7, v4, vcc
  v_or_b32 v9, v9, v26
  s_or_b64 vcc, vcc, s[14:15]
  v_cndmask_b32 v26, 0, 64, vcc
  v_or_b32 v25, v25, v26
  v_lshl_or_b32 v24, v25, 6, v24
  v_and_b32 v25, 32, v13
  v_lshl_or_b32 v24, v25, 10, v24
  v_lshl_or_b32 v9, v9, 16, v24
  v_lshrrev_b32 v18, 4, v14
  v_and_b32 v18, 0x3fc, v18
  ds_add_rtn_u32 v22, v18, v5 offset:0
  v_sub_u32 v24, v10, v14
  v_and_b32 v24, 31, v24
  v_lshrrev_b32 v26, 5, v10
  v_or_b32 v26, 1, v26
  v_mul_u32_u24 v26, 1338, v26
  v_cmp_le_u32 s[14:15], 8, v24
  v_cmp_gt_u16 vcc, 0xa740, v26
  v_and_b32 v25, 63, v14
  s_nop 0
  v_cndmask_b32 v26, v7, v4, vcc
  v_or_b32 v10, v10, v26
  s_or_b64 vcc, vcc, s[14:15]
  v_cndmask_b32 v26, 0, 64, vcc
  v_or_b32 v25, v25, v26
  v_lshl_or_b32 v24, v25, 6, v24
  v_and_b32 v25, 32, v14
  v_lshl_or_b32 v24, v25, 10, v24
  v_lshl_or_b32 v10, v10, 16, v24
  v_lshrrev_b32 v19, 4, v15
  v_and_b32 v19, 0x3fc, v19
  ds_add_rtn_u32 v23, v19, v5 offset:0
  v_sub_u32 v24, v11, v15
  v_and_b32 v24, 31, v24
  v_lshrrev_b32 v26, 5, v11
  v_or_b32 v26, 1, v26
  v_mul_u32_u24 v26, 1338, v26
  v_cmp_le_u32 s[14:15], 8, v24
  v_cmp_gt_u16 vcc, 0xa740, v26
  v_and_b32 v25, 63, v15
  s_nop 0
  v_cndmask_b32 v26, v7, v4, vcc
  v_or_b32 v11, v11, v26
  s_or_b64 vcc, vcc, s[14:15]
  v_cndmask_b32 v26, 0, 64, vcc
  v_or_b32 v25, v25, v26
  v_lshl_or_b32 v24, v25, 6, v24
  v_and_b32 v25, 32, v15
  v_lshl_or_b32 v24, v25, 10, v24
  v_lshl_or_b32 v11, v11, 16, v24
  s_waitcnt lgkmcnt(0)
k1s_c:
  s_mov_b64 exec, -1
  s_barrier
  v_and_b32 v6, 63, v0
  v_lshlrev_b32 v6, 4, v6
  ds_read_b128 v[24:27], v6 offset:0
  s_waitcnt lgkmcnt(0)
  v_add_u32 v29, v24, v25
  v_add_u32 v30, v29, v26
  v_add_u32 v31, v30, v27
  v_mov_b32 v32, v31
  s_nop 1
  v_add_u32_dpp v32, v32, v32 row_shr:1 row_mask:0xf bank_mask:0xf bound_ctrl:0
  s_nop 1
  v_add_u32_dpp v32, v32, v32 row_shr:2 row_mask:0xf bank_mask:0xf bound_ctrl:0
  s_nop 1
  v_add_u32_dpp v32, v32, v32 row_shr:4 row_mask:0xf bank_mask:0xf bound_ctrl:0
  s_nop 1
  v_add_u32_dpp v32, v32, v32 row_shr:8 row_mask:0xf bank_mask:0xf bound_ctrl:0
  s_nop 1
  v_add_u32_dpp v32, v32, v32 row_bcast:15 row_mask:0xa bank_mask:0xf
  s_nop 1
  v_add_u32_dpp v32, v32, v32 row_bcast:31 row_mask:0xc bank_mask:0xf
  v_sub_u32 v36, v32, v31
  v_add_u32 v37, v36, v24
  v_add_u32 v38, v36, v29
  v_add_u32 v39, v36, v30
  ds_write_b128 v6, v[36:39] offset:1024
  v_lshl_or_b32 v40, v37, 16, v36
  v_lshl_or_b32 v41, v38, 16, v37
  v_lshl_or_b32 v42, v39, 16, v38
  v_lshl_or_b32 v43, v32, 16, v39
  v_cmp_gt_u32 vcc, 64, v0
  s_and_saveexec_b64 s[30:31], vcc
  s_cbranch_execz k1s_d
  s_lshl_b32 s5, s3, 10
  s_add_u32 s5, s5, 52980736
  v_add_u32 v7, s5, v6
  global_store_dwordx4 v7, v[40:43], s[26:27]
k1s_d:
  s_mov_b64 exec, s[28:29]
  s_waitcnt lgkmcnt(0)
  s_cbranch_execz k1s_e
  ds_read_b32 v24, v16 offset:1024
  ds_read_b32 v25, v17 offset:1024
  ds_read_b32 v26, v18 offset:1024
  ds_read_b32 v27, v19 offset:1024
  s_waitcnt lgkmcnt(3)
  v_add_lshl_u32 v24, v24, v20, 2
  s_waitcnt lgkmcnt(2)
  v_add_lshl_u32 v25, v25, v21, 2
  s_waitcnt lgkmcnt(1)
  v_add_lshl_u32 v26, v26, v22, 2
  s_waitcnt lgkmcnt(0)
  v_add_lshl_u32 v27, v27, v23, 2
  ds_write_b32 v24, v8 offset:2048
  ds_write_b32 v25, v9 offset:2048
  ds_write_b32 v26, v10 offset:2048
  ds_write_b32 v27, v11 offset:2048
  s_waitcnt lgkmcnt(0)
k1s_e:
  s_barrier
  s_cbranch_execz k1_end
  ds_read_b128 v[8:11], v1 offset:2048
  v_add_u32 v2, 51380224, v2
  s_waitcnt lgkmcnt(0)
  global_store_dwordx4 v2, v[8:11], s[26:27]
  s_endpgm
k1_end:
  s_endpgm
.globl k2_kernel
.p2align 8
.type k2_kernel,@function
k2_kernel:
  s_cmp_ge_u32 s2, 248
  s_cbranch_scc1 k2_end
  s_cmp_lt_u32 s2, 3
  s_cbranch_scc1 k1_w
  s_cmp_ge_u32 s2, 199
  s_cbranch_scc1 k1_tr
  s_sub_u32 s28, s2, 3
  s_load_dwordx2 s[4:5], s[0:1], 88
  v_lshrrev_b32 v1, 2, v0
  v_and_b32 v2, 3, v0
  s_lshl_b32 s3, s28, 2
  s_add_u32 s3, s3, 52980736
  v_min_u32 v5, 249, v1
  v_lshl_add_u32 v3, v5, 10, s3
  v_mul_u32_u24 v5, 6400, v5
  v_lshl_add_u32 v5, v2, 4, v5
  v_add_u32 v5, 51380224, v5
  v_lshlrev_b32 v6, 3, v0
  v_mov_b32 v8, -1
  v_mov_b32 v9, -1
  s_waitcnt lgkmcnt(0)
  global_load_dword v4, v3, s[4:5]
  ds_write_b64 v6, v[8:9] offset:0
  v_mov_b32 v10, 0
  v_mov_b32 v11, 0
  v_cmp_gt_u32 vcc, 194, v0
  s_and_saveexec_b64 s[6:7], vcc
  ds_write_b64 v6, v[10:11] offset:16384
  s_mov_b64 exec, -1
  v_cmp_gt_u32 vcc, 250, v1
  v_lshrrev_b32 v7, 6, v0
  v_lshlrev_b32 v7, 2, v7
  v_mov_b32 v30, 1
  s_waitcnt vmcnt(0)
  v_cndmask_b32 v4, 0, v4, vcc
  v_and_b32 v12, 0xffff, v4
  v_lshrrev_b32 v13, 16, v4
  v_sub_u32 v13, v13, v12
  v_lshlrev_b32 v14, 2, v2
  v_sub_u32 v13, v13, v14
  v_lshl_add_u32 v5, v12, 2, v5
  global_load_dwordx4 v[16:19], v5, s[4:5]
  v_cmp_lt_i32 vcc, 16, v13
  s_and_saveexec_b64 s[6:7], vcc
  s_cbranch_execz k2_a
  global_load_dwordx4 v[20:23], v5, s[4:5] offset:64
k2_a:
  s_mov_b64 exec, -1
  v_cmp_eq_u32 vcc, 0, v2
  s_nop 1
  v_cndmask_b32 v12, 0, v12, vcc
  s_nop 1
  v_add_u32_dpp v12, v12, v12 row_shr:1 row_mask:0xf bank_mask:0xf
  s_nop 1
  v_add_u32_dpp v12, v12, v12 row_shr:2 row_mask:0xf bank_mask:0xf
  s_nop 1
  v_add_u32_dpp v12, v12, v12 row_shr:4 row_mask:0xf bank_mask:0xf
  s_nop 1
  v_add_u32_dpp v12, v12, v12 row_shr:8 row_mask:0xf bank_mask:0xf
  s_nop 1
  v_add_u32_dpp v12, v12, v12 row_bcast:15 row_mask:0xa bank_mask:0xf
  s_nop 1
  v_add_u32_dpp v12, v12, v12 row_bcast:31 row_mask:0xc bank_mask:0xf
  s_mov_b32 exec_lo, 0
  s_brev_b32 exec_hi, 1
  ds_write_b32 v7, v12 offset:17984
  s_mov_b64 exec, -1
  s_waitcnt lgkmcnt(0)
  s_barrier
  s_waitcnt vmcnt(0)
k2_loop:
  s_waitcnt vmcnt(0)
  v_cmp_lt_i32 s[10:11], 0, v13
  v_bfe_u32 v24, v16, 12, 1
  v_lshlrev_b32 v24, v16, v24
  v_lshrrev_b32 v32, 3, v16
  v_and_b32 v32, 0x1f8, v32
  v_cmp_lt_i32 s[12:13], 1, v13
  v_bfe_u32 v25, v17, 12, 1
  v_lshlrev_b32 v25, v17, v25
  v_lshrrev_b32 v33, 3, v17
  v_and_b32 v33, 0x1f8, v33
  v_cmp_lt_i32 s[14:15], 2, v13
  v_bfe_u32 v26, v18, 12, 1
  v_lshlrev_b32 v26, v18, v26
  v_lshrrev_b32 v34, 3, v18
  v_and_b32 v34, 0x1f8, v34
  v_cmp_lt_i32 s[16:17], 3, v13
  v_bfe_u32 v27, v19, 12, 1
  v_lshlrev_b32 v27, v19, v27
  v_lshrrev_b32 v35, 3, v19
  v_and_b32 v35, 0x1f8, v35
  s_mov_b64 exec, s[10:11]
  ds_or_rtn_b32 v36, v32, v24 offset:16384
  s_mov_b64 exec, s[12:13]
  ds_or_rtn_b32 v37, v33, v25 offset:16384
  s_mov_b64 exec, s[14:15]
  ds_or_rtn_b32 v38, v34, v26 offset:16384
  s_mov_b64 exec, s[16:17]
  ds_or_rtn_b32 v39, v35, v27 offset:16384
  s_mov_b64 exec, s[10:11]
  v_and_b32 v28, 0xfff, v16
  v_lshlrev_b32 v28, 1, v28
  v_lshrrev_b32 v29, 12, v16
  v_and_b32 v29, 0x1f8, v29
  s_waitcnt lgkmcnt(0)
  v_bfi_b32 v31, v36, 0, v24
  v_cmp_ne_u32 vcc, 0, v31
  s_andn2_b64 s[10:11], exec, vcc
  s_mov_b64 exec, vcc
  ds_write_b16_d16_hi v28, v16 offset:0
  ds_or_b32 v29, v24 offset:17408
  s_mov_b64 exec, s[10:11]
  ds_add_rtn_u32 v36, v32, v30 offset:16896
  s_mov_b64 exec, s[12:13]
  v_and_b32 v28, 0xfff, v17
  v_lshlrev_b32 v28, 1, v28
  v_lshrrev_b32 v29, 12, v17
  v_and_b32 v29, 0x1f8, v29
  v_bfi_b32 v31, v37, 0, v25
  v_cmp_ne_u32 vcc, 0, v31
  s_andn2_b64 s[12:13], exec, vcc
  s_mov_b64 exec, vcc
  ds_write_b16_d16_hi v28, v17 offset:0
  ds_or_b32 v29, v25 offset:17408
  s_mov_b64 exec, s[12:13]
  ds_add_rtn_u32 v37, v33, v30 offset:16896
  s_mov_b64 exec, s[14:15]
  v_and_b32 v28, 0xfff, v18
  v_lshlrev_b32 v28, 1, v28
  v_lshrrev_b32 v29, 12, v18
  v_and_b32 v29, 0x1f8, v29
  v_bfi_b32 v31, v38, 0, v26
  v_cmp_ne_u32 vcc, 0, v31
  s_andn2_b64 s[14:15], exec, vcc
  s_mov_b64 exec, vcc
  ds_write_b16_d16_hi v28, v18 offset:0
  ds_or_b32 v29, v26 offset:17408
  s_mov_b64 exec, s[14:15]
  ds_add_rtn_u32 v38, v34, v30 offset:16896
  s_mov_b64 exec, s[16:17]
  v_and_b32 v28, 0xfff, v19
  v_lshlrev_b32 v28, 1, v28
  v_lshrrev_b32 v29, 12, v19
  v_and_b32 v29, 0x1f8, v29
  v_bfi_b32 v31, v39, 0, v27
  v_cmp_ne_u32 vcc, 0, v31
  s_andn2_b64 s[16:17], exec, vcc
  s_mov_b64 exec, vcc
  ds_write_b16_d16_hi v28, v19 offset:0
  ds_or_b32 v29, v27 offset:17408
  s_mov_b64 exec, s[16:17]
  ds_add_rtn_u32 v39, v35, v30 offset:16896
  s_mov_b64 exec, s[10:11]
  v_and_b32 v28, 0xfc0, v16
  s_waitcnt lgkmcnt(0)
  v_add_lshl_u32 v28, v28, v36, 1
  v_cmp_gt_u32 vcc, 64, v36
  s_andn2_b64 s[10:11], exec, vcc
  s_mov_b64 exec, vcc
  ds_write_b16_d16_hi v28, v16 offset:8192
  s_mov_b64 exec, s[12:13]
  v_and_b32 v28, 0xfc0, v17
  v_add_lshl_u32 v28, v28, v37, 1
  v_cmp_gt_u32 vcc, 64, v37
  s_andn2_b64 s[12:13], exec, vcc
  s_mov_b64 exec, vcc
  ds_write_b16_d16_hi v28, v17 offset:8192
  s_mov_b64 exec, s[14:15]
  v_and_b32 v28, 0xfc0, v18
  v_add_lshl_u32 v28, v28, v38, 1
  v_cmp_gt_u32 vcc, 64, v38
  s_andn2_b64 s[14:15], exec, vcc
  s_mov_b64 exec, vcc
  ds_write_b16_d16_hi v28, v18 offset:8192
  s_mov_b64 exec, s[16:17]
  v_and_b32 v28, 0xfc0, v19
  v_add_lshl_u32 v28, v28, v39, 1
  v_cmp_gt_u32 vcc, 64, v39
  s_andn2_b64 s[16:17], exec, vcc
  s_mov_b64 exec, vcc
  ds_write_b16_d16_hi v28, v19 offset:8192
  s_or_b64 s[6:7], s[10:11], s[12:13]
  s_or_b64 s[8:9], s[14:15], s[16:17]
  s_or_b64 s[6:7], s[6:7], s[8:9]
  s_cbranch_scc1 k2_slow1
k2_b:
  s_mov_b64 exec, -1
  v_subrev_u32 v13, 16, v13
  v_cmp_lt_i32 vcc, 0, v13
  s_cbranch_vccz k2_p2
  v_mov_b32 v16, v20
  v_mov_b32 v17, v21
  v_mov_b32 v18, v22
  v_mov_b32 v19, v23
  v_add_u32 v5, 64, v5
  v_cmp_lt_i32 vcc, 16, v13
  s_and_saveexec_b64 s[6:7], vcc
  s_cbranch_execz k2_c
  global_load_dwordx4 v[20:23], v5, s[4:5] offset:64
k2_c:
  s_mov_b64 exec, -1
  s_branch k2_loop
k2_slow1:
  s_mov_b64 exec, s[10:11]
  s_cbranch_execz k2_s1_0
  v_mov_b32 v40, 0
  v_mov_b32 v41, 1
  ds_read_b128 v[44:47], v40 offset:17984
  ds_read_b128 v[48:51], v40 offset:18000
  ds_read_b128 v[52:55], v40 offset:18016
  ds_read_b128 v[56:59], v40 offset:18032
  ds_add_rtn_u32 v42, v40, v41 offset:17920
  s_waitcnt lgkmcnt(0)
  v_add3_u32 v42, v42, v44, v45
  v_add3_u32 v42, v42, v46, v47
  v_add3_u32 v42, v42, v48, v49
  v_add3_u32 v42, v42, v50, v51
  v_add3_u32 v42, v42, v52, v53
  v_add3_u32 v42, v42, v54, v55
  v_add3_u32 v42, v42, v56, v57
  v_add3_u32 v42, v42, v58, v59
  v_lshlrev_b32 v42, 2, v42
  v_add_u32 v42, 54846464, v42
  global_store_dword v42, v16, s[4:5]
k2_s1_0:
  s_mov_b64 exec, s[12:13]
  s_cbranch_execz k2_s1_1
  v_mov_b32 v40, 0
  v_mov_b32 v41, 1
  ds_read_b128 v[44:47], v40 offset:17984
  ds_read_b128 v[48:51], v40 offset:18000
  ds_read_b128 v[52:55], v40 offset:18016
  ds_read_b128 v[56:59], v40 offset:18032
  ds_add_rtn_u32 v42, v40, v41 offset:17920
  s_waitcnt lgkmcnt(0)
  v_add3_u32 v42, v42, v44, v45
  v_add3_u32 v42, v42, v46, v47
  v_add3_u32 v42, v42, v48, v49
  v_add3_u32 v42, v42, v50, v51
  v_add3_u32 v42, v42, v52, v53
  v_add3_u32 v42, v42, v54, v55
  v_add3_u32 v42, v42, v56, v57
  v_add3_u32 v42, v42, v58, v59
  v_lshlrev_b32 v42, 2, v42
  v_add_u32 v42, 54846464, v42
  global_store_dword v42, v17, s[4:5]
k2_s1_1:
  s_mov_b64 exec, s[14:15]
  s_cbranch_execz k2_s1_2
  v_mov_b32 v40, 0
  v_mov_b32 v41, 1
  ds_read_b128 v[44:47], v40 offset:17984
  ds_read_b128 v[48:51], v40 offset:18000
  ds_read_b128 v[52:55], v40 offset:18016
  ds_read_b128 v[56:59], v40 offset:18032
  ds_add_rtn_u32 v42, v40, v41 offset:17920
  s_waitcnt lgkmcnt(0)
  v_add3_u32 v42, v42, v44, v45
  v_add3_u32 v42, v42, v46, v47
  v_add3_u32 v42, v42, v48, v49
  v_add3_u32 v42, v42, v50, v51
  v_add3_u32 v42, v42, v52, v53
  v_add3_u32 v42, v42, v54, v55
  v_add3_u32 v42, v42, v56, v57
  v_add3_u32 v42, v42, v58, v59
  v_lshlrev_b32 v42, 2, v42
  v_add_u32 v42, 54846464, v42
  global_store_dword v42, v18, s[4:5]
k2_s1_2:
  s_mov_b64 exec, s[16:17]
  s_cbranch_execz k2_s1_3
  v_mov_b32 v40, 0
  v_mov_b32 v41, 1
  ds_read_b128 v[44:47], v40 offset:17984
  ds_read_b128 v[48:51], v40 offset:18000
  ds_read_b128 v[52:55], v40 offset:18016
  ds_read_b128 v[56:59], v40 offset:18032
  ds_add_rtn_u32 v42, v40, v41 offset:17920
  s_waitcnt lgkmcnt(0)
  v_add3_u32 v42, v42, v44, v45
  v_add3_u32 v42, v42, v46, v47
  v_add3_u32 v42, v42, v48, v49
  v_add3_u32 v42, v42, v50, v51
  v_add3_u32 v42, v42, v52, v53
  v_add3_u32 v42, v42, v54, v55
  v_add3_u32 v42, v42, v56, v57
  v_add3_u32 v42, v42, v58, v59
  v_lshlrev_b32 v42, 2, v42
  v_add_u32 v42, 54846464, v42
  global_store_dword v42, v19, s[4:5]
k2_s1_3:
  s_branch k2_b
k2_p2:
  v_lshrrev_b32 v44, 5, v0
  v_and_b32 v45, 31, v0
  v_mul_u32_u24 v44, 100352, v44
  v_lshl_add_u32 v44, v45, 4, v44
  s_lshl_b32 s3, s28, 9
  s_add_u32 s3, s3, 28901376
  v_add_u32 v44, s3, v44
  v_mov_b32 v36, 0
  v_mov_b32 v37, 0
  v_mov_b32 v38, 0
  v_mov_b32 v39, 0
  global_store_dwordx4 v44, v[36:39], s[4:5] sc1
  v_and_b32 v1, 63, v0
  v_lshlrev_b32 v2, 3, v1
  v_lshrrev_b32 v3, 4, v0
  v_and_b32 v4, 15, v0
  v_lshlrev_b32 v5, 3, v3
  v_lshlrev_b32 v6, 7, v3
  v_lshl_add_u32 v7, v4, 1, v6
  s_waitcnt lgkmcnt(0)
  s_barrier
  ds_read_b32 v8, v2 offset:16384
  ds_read_b32 v9, v2 offset:16896
  ds_read_u16 v16, v7 offset:8192
  ds_read_u16 v17, v7 offset:8224
  ds_read_u16 v18, v7 offset:8256
  ds_read_u16 v19, v7 offset:8288
  ds_read_b64 v[10:11], v5 offset:16384
  ds_read_b32 v12, v5 offset:16896
  v_lshrrev_b32 v15, 5, v3
  v_lshlrev_b32 v15, 3, v15
  v_mul_u32_u24 v20, 11, v3
  v_lshl_add_u32 v20, v4, 2, v20
  v_and_b32 v20, 63, v20
  s_waitcnt lgkmcnt(6)
  v_bcnt_u32_b32 v8, v8, v9
  s_waitcnt lgkmcnt(5)
  v_and_b32 v21, 31, v16
  v_lshl_add_u32 v21, v21, 4, v15
  v_lshl_or_b32 v16, v21, 16, v16
  ds_read_b64 v[24:25], v21 offset:17408
  s_waitcnt lgkmcnt(4)
  v_and_b32 v21, 31, v17
  v_lshl_add_u32 v21, v21, 4, v15
  v_lshl_or_b32 v17, v21, 16, v17
  s_waitcnt lgkmcnt(3)
  v_and_b32 v21, 31, v18
  v_lshl_add_u32 v21, v21, 4, v15
  v_lshl_or_b32 v18, v21, 16, v18
  s_waitcnt lgkmcnt(2)
  v_and_b32 v21, 31, v19
  v_lshl_add_u32 v21, v21, 4, v15
  v_lshl_or_b32 v19, v21, 16, v19
  v_max_u32_dpp v8, v8, v8 row_shr:1 row_mask:0xf bank_mask:0xf
  s_nop 1
  v_max_u32_dpp v8, v8, v8 row_shr:2 row_mask:0xf bank_mask:0xf
  s_nop 1
  v_max_u32_dpp v8, v8, v8 row_shr:4 row_mask:0xf bank_mask:0xf
  s_nop 1
  v_max_u32_dpp v8, v8, v8 row_shr:8 row_mask:0xf bank_mask:0xf
  s_nop 1
  v_max_u32_dpp v8, v8, v8 row_bcast:15 row_mask:0xa bank_mask:0xf
  s_nop 1
  v_max_u32_dpp v8, v8, v8 row_bcast:31 row_mask:0xc bank_mask:0xf
  s_nop 0
  v_readlane_b32 s10, v8, 63
  s_add_u32 s10, s10, 3
  s_and_b32 s10, s10, -4
  s_max_u32 s10, s10, 32
  s_min_u32 s10, s10, 64
  s_sub_u32 s11, s10, 32
  s_lshl_b64 s[12:13], 1, s11
  s_sub_u32 s12, s12, 1
  s_mul_i32 s14, s10, 27
  s_lshr_b32 s14, s14, 6
  s_sub_u32 s15, s14, s10
  v_mul_u32_u24 v20, s10, v20
  v_lshrrev_b32 v20, 6, v20
  s_waitcnt lgkmcnt(0)
  v_bcnt_u32_b32 v21, v10, 0
  v_sub_u32 v21, s10, v21
  v_min_u32 v12, 64, v12
  v_min_u32 v13, v21, v12
  v_cmp_lt_u32 vcc, v13, v12
  s_cbranch_vccnz k2_slow2
k2_d:
  s_mov_b32 s29, 255
  v_lshrrev_b32 v21, 8, v10
  v_bcnt_u32_b32 v21, v21, v13
  s_sub_u32 s30, s10, 8
  v_cmp_ge_u32 vcc, s30, v21
  s_nop 1
  v_cndmask_b32 v42, 0, -1, vcc
  v_or_b32 v43, 7, v42
  v_sub_u32 v13, v13, v4
  v_mov_b32 v14, 0
  v_cmp_lt_i32 vcc, 0, v13
  s_and_b64 exec, vcc, vcc
  s_cbranch_execz k2_p3
k2_round:
  v_bfe_i32 v36, v16, 15, 1
  v_not_b32 v28, v10
  v_bitop3_b32 v29, v11, v11, s12 bitop3:0x02
  v_bitop3_b32 v37, v36, v42, s29 bitop3:0x5e
  v_and_b32 v38, v37, v28
  v_bitop3_b32 v39, v36, v42, v29 bitop3:0xa8
  v_cmp_eq_u64 vcc, 0, v[38:39]
  v_bitop3_b32 v40, v20, v36, v43 bitop3:0xe0
  s_nop 0
  v_cndmask_b32 v28, v38, v28, vcc
  v_cndmask_b32 v29, v39, v29, vcc
  v_cndmask_b32 v40, v40, v20, vcc
  v_bfi_b32 v26, v24, 0, v28
  v_bfi_b32 v27, v25, 0, v29
  v_cmp_eq_u64 vcc, 0, v[26:27]
  s_nop 1
  v_cndmask_b32 v37, 0, 4, vcc
  v_add_u32 v14, v14, v37
  v_cmp_le_u32 s[16:17], 4, v14
  s_and_b64 vcc, vcc, s[16:17]
  v_cndmask_b32 v26, v26, v28, vcc
  v_cndmask_b32 v27, v27, v29, vcc
  v_lshlrev_b64 v[28:29], v40, -1
  v_and_b32 v28, v28, v26
  v_and_b32 v29, v29, v27
  v_cmp_ne_u64 vcc, 0, v[28:29]
  s_nop 1
  v_cndmask_b32 v26, v26, v28, vcc
  v_cndmask_b32 v27, v27, v29, vcc
  v_ffbl_b32 v28, v26
  v_ffbl_b32 v29, v27
  v_or_b32 v29, 32, v29
  v_min_u32 v28, v28, v29
  v_lshlrev_b64 v[32:33], v28, 1
  v_and_b32 v32, v32, v26
  v_and_b32 v33, v33, v27
  v_bfe_u32 v22, v16, 16, 9
  v_bfe_u32 v23, v17, 16, 9
  ds_or_rtn_b64 v[10:11], v5, v[32:33] offset:16384
  ds_or_rtn_b64 v[24:25], v22, v[32:33] offset:17408
  ds_read_b64 v[34:35], v23 offset:17408
  v_cmp_le_i32 s[18:19], 0, v28
  v_lshl_add_u32 v29, v28, 1, v6
  v_add_u32 v26, s14, v20
  v_add_u32 v27, s15, v20
  v_min_u32 v20, v26, v27
  v_add_u32 v14, 1, v14
  s_waitcnt lgkmcnt(2)
  v_and_b32 v26, v10, v32
  v_and_or_b32 v26, v11, v33, v26
  v_cmp_eq_u32 s[20:21], 0, v26
  v_or_b32 v10, v10, v32
  v_or_b32 v11, v11, v33
  s_waitcnt lgkmcnt(0)
  v_and_b32 v26, v24, v32
  v_and_or_b32 v26, v25, v33, v26
  v_cmp_eq_u32 vcc, 0, v26
  s_mov_b64 s[24:25], exec
  s_or_b64 s[22:23], vcc, s[16:17]
  s_and_b64 s[22:23], s[22:23], s[20:21]
  s_and_b64 s[22:23], s[22:23], s[18:19]
  s_andn2_b64 exec, s[20:21], s[22:23]
  ds_xor_b64 v5, v[32:33] offset:16384
  s_andn2_b64 exec, vcc, s[22:23]
  ds_xor_b64 v22, v[32:33] offset:17408
  s_mov_b64 exec, s[22:23]
  ds_write_b16 v29, v16 offset:0
  v_mov_b32 v16, v17
  v_mov_b32 v17, v18
  v_mov_b32 v18, v19
  v_mov_b32 v14, 0
  v_subrev_u32 v13, 16, v13
  v_mov_b32 v24, v34
  v_mov_b32 v25, v35
  s_mov_b64 exec, s[24:25]
  v_cmp_lt_i32 vcc, 0, v13
  s_and_b64 exec, vcc, vcc
  s_cbranch_execnz k2_round
k2_p3:
  s_mov_b64 exec, -1
  v_and_b32 v8, 31, v1
  v_lshrrev_b32 v9, 5, v1
  v_lshlrev_b32 v8, 4, v8
  v_lshl_add_u32 v8, v9, 3, v8
  v_lshrrev_b32 v10, 6, v0
  s_nop 0
  v_readfirstlane_b32 s11, v10
  s_lshr_b32 s12, s11, 3
  s_lshl_b32 s12, s12, 2
  v_add_u32 v8, s12, v8
  s_and_b32 s12, s11, 7
  s_lshl_b32 s12, s12, 2
  s_waitcnt lgkmcnt(0)
  s_barrier
  ds_read_b32 v10, v8 offset:17408
  v_lshlrev_b32 v9, 7, v9
  s_lshl_b32 s13, s11, 3
  v_add_u32 v9, s13, v9
  s_waitcnt lgkmcnt(0)
  v_lshrrev_b32 v10, s12, v10
  v_and_b32 v11, 1, v10
  v_cmp_ne_u32 s[16:17], 0, v11
  v_and_b32 v11, 2, v10
  v_cmp_ne_u32 s[18:19], 0, v11
  v_and_b32 v11, 4, v10
  v_cmp_ne_u32 s[20:21], 0, v11
  v_and_b32 v11, 8, v10
  v_cmp_ne_u32 s[22:23], 0, v11
  s_ff0_i32_b32 s16, s16
  s_and_b32 s16, s16, 31
  s_ff0_i32_b32 s17, s17
  s_and_b32 s17, s17, 31
  s_ff0_i32_b32 s18, s18
  s_and_b32 s18, s18, 31
  s_ff0_i32_b32 s19, s19
  s_and_b32 s19, s19, 31
  s_ff0_i32_b32 s20, s20
  s_and_b32 s20, s20, 31
  s_ff0_i32_b32 s21, s21
  s_and_b32 s21, s21, 31
  s_ff0_i32_b32 s22, s22
  s_and_b32 s22, s22, 31
  s_ff0_i32_b32 s23, s23
  s_and_b32 s23, s23, 31
  s_pack_ll_b32_b16 s24, s16, s18
  s_pack_ll_b32_b16 s25, s20, s22
  s_pack_ll_b32_b16 s26, s17, s19
  s_pack_ll_b32_b16 s27, s21, s23
  s_add_u32 s24, s24, 819998944
  s_add_u32 s25, s25, 819998944
  s_add_u32 s26, s26, 819998944
  s_add_u32 s27, s27, 819998944
  v_mov_b32 v12, s24
  v_mov_b32 v13, s25
  v_writelane_b32 v12, s26, 32
  v_writelane_b32 v13, s27, 32
  s_mov_b32 exec_lo, 1
  s_mov_b32 exec_hi, 1
  ds_write_b64 v9, v[12:13] offset:18048
  s_mov_b64 exec, -1
  s_waitcnt lgkmcnt(0)
  s_barrier
  s_cmp_ge_u32 s11, 9
  s_cbranch_scc1 k2_end
  s_cmp_eq_u32 s11, 8
  s_cbranch_scc1 k2_meta
  v_lshlrev_b32 v1, 4, v0
  v_and_b32 v2, 7, v0
  v_lshrrev_b32 v3, 8, v0
  v_lshlrev_b32 v3, 7, v3
  v_lshl_add_u32 v3, v2, 4, v3
  ds_read_b128 v[8:11], v1 offset:0
  ds_read_b128 v[12:15], v3 offset:18048
  v_lshrrev_b32 v4, 3, v0
  v_lshlrev_b32 v4, 4, v4
  v_lshl_add_u32 v4, v2, 10, v4
  s_lshl_b32 s12, s28, 13
  s_mov_b32 s13, 0x7fff7fff
  s_add_u32 s12, s12, 53236736
  v_add_u32 v4, s12, v4
  v_lshlrev_b32 v2, 3, v2
  v_cmp_gt_u32 vcc, s10, v2
  s_and_b64 exec, vcc, vcc
  s_waitcnt lgkmcnt(0)
  v_and_b32 v8, s13, v8
  v_and_b32 v9, s13, v9
  v_and_b32 v10, s13, v10
  v_and_b32 v11, s13, v11
  v_pk_min_u16 v8, v8, v12
  v_pk_min_u16 v9, v9, v13
  v_pk_min_u16 v10, v10, v14
  v_pk_min_u16 v11, v11, v15
  global_store_dwordx4 v4, v[8:11], s[4:5]
  s_endpgm
k2_meta:
  v_mov_b32 v40, 0
  ds_read_b128 v[44:47], v40 offset:17984
  ds_read_b128 v[48:51], v40 offset:18000
  ds_read_b128 v[52:55], v40 offset:18016
  ds_read_b128 v[56:59], v40 offset:18032
  ds_read_b32 v42, v40 offset:17920
  v_lshlrev_b32 v1, 7, v1
  ds_read_b128 v[8:11], v1 offset:0
  ds_read_b128 v[12:15], v1 offset:16
  v_mov_b32 v41, 0
  v_mov_b32 v43, 0
  s_lshl_b32 s12, s28, 4
  s_add_u32 s12, s12, 54842368
  v_mov_b32 v4, s12
  s_waitcnt lgkmcnt(0)
  v_add3_u32 v41, v41, v44, v45
  v_add3_u32 v41, v41, v46, v47
  v_add3_u32 v41, v41, v48, v49
  v_add3_u32 v41, v41, v50, v51
  v_add3_u32 v41, v41, v52, v53
  v_add3_u32 v41, v41, v54, v55
  v_add3_u32 v41, v41, v56, v57
  v_add3_u32 v41, v41, v58, v59
  v_lshlrev_b32 v16, 1, v8
  v_bitop3_b32 v43, v8, v16, v43 bitop3:0xba
  v_lshlrev_b32 v16, 1, v9
  v_bitop3_b32 v43, v9, v16, v43 bitop3:0xba
  v_lshlrev_b32 v16, 1, v10
  v_bitop3_b32 v43, v10, v16, v43 bitop3:0xba
  v_lshlrev_b32 v16, 1, v11
  v_bitop3_b32 v43, v11, v16, v43 bitop3:0xba
  v_and_b32 v43, 0x80008000, v43
  v_cmp_ne_u32 vcc, 0, v43
  s_or_b32 s12, vcc_lo, vcc_hi
  v_mov_b32 v43, s12
  v_mov_b32 v40, s10
  s_mov_b64 exec, 1
  global_store_dwordx4 v4, v[40:43], s[4:5]
  s_endpgm
k2_slow2:
  v_add_u32 v21, 0, v4
  v_cmp_ge_u32 vcc, v21, v13
  v_cmp_lt_u32 s[16:17], v21, v12
  s_and_b64 exec, vcc, s[16:17]
  s_cbranch_execz k2_s2_0
  v_lshlrev_b32 v22, 6, v3
  v_lshl_or_b32 v22, v16, 16, v22
  v_mov_b32 v40, 0
  v_mov_b32 v41, 1
  ds_read_b128 v[44:47], v40 offset:17984
  ds_read_b128 v[48:51], v40 offset:18000
  ds_read_b128 v[52:55], v40 offset:18016
  ds_read_b128 v[56:59], v40 offset:18032
  ds_add_rtn_u32 v42, v40, v41 offset:17920
  s_waitcnt lgkmcnt(0)
  v_add3_u32 v42, v42, v44, v45
  v_add3_u32 v42, v42, v46, v47
  v_add3_u32 v42, v42, v48, v49
  v_add3_u32 v42, v42, v50, v51
  v_add3_u32 v42, v42, v52, v53
  v_add3_u32 v42, v42, v54, v55
  v_add3_u32 v42, v42, v56, v57
  v_add3_u32 v42, v42, v58, v59
  v_lshlrev_b32 v42, 2, v42
  v_add_u32 v42, 54846464, v42
  global_store_dword v42, v22, s[4:5]
k2_s2_0:
  s_mov_b64 exec, -1
  v_add_u32 v21, 16, v4
  v_cmp_ge_u32 vcc, v21, v13
  v_cmp_lt_u32 s[16:17], v21, v12
  s_and_b64 exec, vcc, s[16:17]
  s_cbranch_execz k2_s2_1
  v_lshlrev_b32 v22, 6, v3
  v_lshl_or_b32 v22, v17, 16, v22
  v_mov_b32 v40, 0
  v_mov_b32 v41, 1
  ds_read_b128 v[44:47], v40 offset:17984
  ds_read_b128 v[48:51], v40 offset:18000
  ds_read_b128 v[52:55], v40 offset:18016
  ds_read_b128 v[56:59], v40 offset:18032
  ds_add_rtn_u32 v42, v40, v41 offset:17920
  s_waitcnt lgkmcnt(0)
  v_add3_u32 v42, v42, v44, v45
  v_add3_u32 v42, v42, v46, v47
  v_add3_u32 v42, v42, v48, v49
  v_add3_u32 v42, v42, v50, v51
  v_add3_u32 v42, v42, v52, v53
  v_add3_u32 v42, v42, v54, v55
  v_add3_u32 v42, v42, v56, v57
  v_add3_u32 v42, v42, v58, v59
  v_lshlrev_b32 v42, 2, v42
  v_add_u32 v42, 54846464, v42
  global_store_dword v42, v22, s[4:5]
k2_s2_1:
  s_mov_b64 exec, -1
  v_add_u32 v21, 32, v4
  v_cmp_ge_u32 vcc, v21, v13
  v_cmp_lt_u32 s[16:17], v21, v12
  s_and_b64 exec, vcc, s[16:17]
  s_cbranch_execz k2_s2_2
  v_lshlrev_b32 v22, 6, v3
  v_lshl_or_b32 v22, v18, 16, v22
  v_mov_b32 v40, 0
  v_mov_b32 v41, 1
  ds_read_b128 v[44:47], v40 offset:17984
  ds_read_b128 v[48:51], v40 offset:18000
  ds_read_b128 v[52:55], v40 offset:18016
  ds_read_b128 v[56:59], v40 offset:18032
  ds_add_rtn_u32 v42, v40, v41 offset:17920
  s_waitcnt lgkmcnt(0)
  v_add3_u32 v42, v42, v44, v45
  v_add3_u32 v42, v42, v46, v47
  v_add3_u32 v42, v42, v48, v49
  v_add3_u32 v42, v42, v50, v51
  v_add3_u32 v42, v42, v52, v53
  v_add3_u32 v42, v42, v54, v55
  v_add3_u32 v42, v42, v56, v57
  v_add3_u32 v42, v42, v58, v59
  v_lshlrev_b32 v42, 2, v42
  v_add_u32 v42, 54846464, v42
  global_store_dword v42, v22, s[4:5]
k2_s2_2:
  s_mov_b64 exec, -1
  v_add_u32 v21, 48, v4
  v_cmp_ge_u32 vcc, v21, v13
  v_cmp_lt_u32 s[16:17], v21, v12
  s_and_b64 exec, vcc, s[16:17]
  s_cbranch_execz k2_s2_3
  v_lshlrev_b32 v22, 6, v3
  v_lshl_or_b32 v22, v19, 16, v22
  v_mov_b32 v40, 0
  v_mov_b32 v41, 1
  ds_read_b128 v[44:47], v40 offset:17984
  ds_read_b128 v[48:51], v40 offset:18000
  ds_read_b128 v[52:55], v40 offset:18016
  ds_read_b128 v[56:59], v40 offset:18032
  ds_add_rtn_u32 v42, v40, v41 offset:17920
  s_waitcnt lgkmcnt(0)
  v_add3_u32 v42, v42, v44, v45
  v_add3_u32 v42, v42, v46, v47
  v_add3_u32 v42, v42, v48, v49
  v_add3_u32 v42, v42, v50, v51
  v_add3_u32 v42, v42, v52, v53
  v_add3_u32 v42, v42, v54, v55
  v_add3_u32 v42, v42, v56, v57
  v_add3_u32 v42, v42, v58, v59
  v_lshlrev_b32 v42, 2, v42
  v_add_u32 v42, 54846464, v42
  global_store_dword v42, v22, s[4:5]
k2_s2_3:
  s_mov_b64 exec, -1
  s_branch k2_d
k1_tr:
  s_load_dwordx2 s[8:9], s[0:1], 0
  s_load_dwordx2 s[14:15], s[0:1], 24
  s_load_dwordx2 s[26:27], s[0:1], 88
  s_sub_u32 s3, s2, 199
  v_and_b32 v1, 63, v0
  v_bfe_u32 v2, v0, 6, 3
  v_lshrrev_b32 v3, 9, v0
  v_lshl_add_u32 v3, v3, 6, v1
  v_lshl_add_u32 v3, s3, 8, v3
  v_lshlrev_b32 v4, 8, v3
  v_lshl_add_u32 v4, v2, 5, v4
  v_add_u32 v44, 0x8000, v4
  v_lshlrev_b32 v5, 1, v3
  v_lshrrev_b32 v6, 2, v2
  v_and_b32 v7, 3, v2
  v_lshl_add_u32 v6, v6, 4, v7
  v_mul_u32_u24 v6, 100352, v6
  v_lshl_add_u32 v6, v3, 3, v6
  s_mov_b32 s4, 0x05040100
  s_mov_b32 s5, 0x07060302
  v_mov_b32 v48, 0
  v_mov_b32 v49, 0
  v_mov_b32 v50, 0
  v_mov_b32 v51, 0
  v_mov_b32 v52, 0
  v_mov_b32 v53, 0
  v_mov_b32 v54, 0
  v_mov_b32 v55, 0
  v_mov_b32 v56, 0
  v_mov_b32 v16, 0
  v_cmp_gt_u32 vcc, 12372, v3
  s_waitcnt lgkmcnt(0)
  global_load_dwordx4 v[8:11], v4, s[8:9]
  global_load_dwordx4 v[12:15], v4, s[8:9] offset:16
  global_load_short_d16_hi v16, v5, s[14:15]
  s_and_saveexec_b64 s[30:31], vcc
  s_cbranch_execz k1t_a
  global_load_dwordx4 v[48:51], v44, s[8:9]
  global_load_dwordx4 v[52:55], v44, s[8:9] offset:16
  global_load_short_d16_hi v56, v5, s[14:15] offset:256
k1t_a:
  s_mov_b64 exec, -1
  v_add_u32 v7, 401408, v6
  v_add_u32 v17, 802816, v6
  v_add_u32 v18, 1204224, v6
  s_add_u32 s28, s26, 25690112
  s_addc_u32 s29, s27, 0
  s_waitcnt vmcnt(0)
  v_perm_b32 v32, v10, v8, s4
  v_perm_b32 v33, v14, v12, s4
  v_perm_b32 v34, v10, v8, s5
  v_perm_b32 v35, v14, v12, s5
  v_perm_b32 v36, v11, v9, s4
  v_perm_b32 v37, v15, v13, s4
  v_perm_b32 v38, v11, v9, s5
  v_perm_b32 v39, v15, v13, s5
  v_lshlrev_b32 v20, 16, v32
  v_and_b32 v21, 0xffff0000, v32
  v_mul_f32 v20, v20, v16
  v_mul_f32 v21, v21, v16
  v_add_u32 v20, 0x10000, v20
  v_and_b32 v20, 0xfffe0000, v20
  v_cvt_pk_bf16_f32 v24, v20, v21
  v_lshlrev_b32 v20, 16, v33
  v_and_b32 v21, 0xffff0000, v33
  v_mul_f32 v20, v20, v16
  v_mul_f32 v21, v21, v16
  v_cvt_pk_bf16_f32 v25, v20, v21
  v_lshlrev_b32 v20, 16, v34
  v_and_b32 v21, 0xffff0000, v34
  v_mul_f32 v20, v20, v16
  v_mul_f32 v21, v21, v16
  v_add_u32 v20, 0x10000, v20
  v_and_b32 v20, 0xfffe0000, v20
  v_cvt_pk_bf16_f32 v26, v20, v21
  v_lshlrev_b32 v20, 16, v35
  v_and_b32 v21, 0xffff0000, v35
  v_mul_f32 v20, v20, v16
  v_mul_f32 v21, v21, v16
  v_cvt_pk_bf16_f32 v27, v20, v21
  v_lshlrev_b32 v20, 16, v36
  v_and_b32 v21, 0xffff0000, v36
  v_mul_f32 v20, v20, v16
  v_mul_f32 v21, v21, v16
  v_add_u32 v20, 0x10000, v20
  v_and_b32 v20, 0xfffe0000, v20
  v_cvt_pk_bf16_f32 v28, v20, v21
  v_lshlrev_b32 v20, 16, v37
  v_and_b32 v21, 0xffff0000, v37
  v_mul_f32 v20, v20, v16
  v_mul_f32 v21, v21, v16
  v_cvt_pk_bf16_f32 v29, v20, v21
  v_lshlrev_b32 v20, 16, v38
  v_and_b32 v21, 0xffff0000, v38
  v_mul_f32 v20, v20, v16
  v_mul_f32 v21, v21, v16
  v_add_u32 v20, 0x10000, v20
  v_and_b32 v20, 0xfffe0000, v20
  v_cvt_pk_bf16_f32 v30, v20, v21
  v_lshlrev_b32 v20, 16, v39
  v_and_b32 v21, 0xffff0000, v39
  v_mul_f32 v20, v20, v16
  v_mul_f32 v21, v21, v16
  v_cvt_pk_bf16_f32 v31, v20, v21
  global_store_dwordx2 v6, v[24:25], s[28:29] offset:0 sc1
  global_store_dwordx2 v7, v[26:27], s[28:29] offset:0 sc1
  global_store_dwordx2 v17, v[28:29], s[28:29] offset:0 sc1
  global_store_dwordx2 v18, v[30:31], s[28:29] offset:0 sc1
  global_store_dwordx2 v6, v[32:33], s[26:27] offset:0 sc1
  global_store_dwordx2 v7, v[34:35], s[26:27] offset:0 sc1
  global_store_dwordx2 v17, v[36:37], s[26:27] offset:0 sc1
  global_store_dwordx2 v18, v[38:39], s[26:27] offset:0 sc1
  v_perm_b32 v72, v50, v48, s4
  v_perm_b32 v73, v54, v52, s4
  v_perm_b32 v74, v50, v48, s5
  v_perm_b32 v75, v54, v52, s5
  v_perm_b32 v76, v51, v49, s4
  v_perm_b32 v77, v55, v53, s4
  v_perm_b32 v78, v51, v49, s5
  v_perm_b32 v79, v55, v53, s5
  v_lshlrev_b32 v20, 16, v72
  v_and_b32 v21, 0xffff0000, v72
  v_mul_f32 v20, v20, v56
  v_mul_f32 v21, v21, v56
  v_add_u32 v20, 0x10000, v20
  v_and_b32 v20, 0xfffe0000, v20
  v_cvt_pk_bf16_f32 v64, v20, v21
  v_lshlrev_b32 v20, 16, v73
  v_and_b32 v21, 0xffff0000, v73
  v_mul_f32 v20, v20, v56
  v_mul_f32 v21, v21, v56
  v_cvt_pk_bf16_f32 v65, v20, v21
  v_lshlrev_b32 v20, 16, v74
  v_and_b32 v21, 0xffff0000, v74
  v_mul_f32 v20, v20, v56
  v_mul_f32 v21, v21, v56
  v_add_u32 v20, 0x10000, v20
  v_and_b32 v20, 0xfffe0000, v20
  v_cvt_pk_bf16_f32 v66, v20, v21
  v_lshlrev_b32 v20, 16, v75
  v_and_b32 v21, 0xffff0000, v75
  v_mul_f32 v20, v20, v56
  v_mul_f32 v21, v21, v56
  v_cvt_pk_bf16_f32 v67, v20, v21
  v_lshlrev_b32 v20, 16, v76
  v_and_b32 v21, 0xffff0000, v76
  v_mul_f32 v20, v20, v56
  v_mul_f32 v21, v21, v56
  v_add_u32 v20, 0x10000, v20
  v_and_b32 v20, 0xfffe0000, v20
  v_cvt_pk_bf16_f32 v68, v20, v21
  v_lshlrev_b32 v20, 16, v77
  v_and_b32 v21, 0xffff0000, v77
  v_mul_f32 v20, v20, v56
  v_mul_f32 v21, v21, v56
  v_cvt_pk_bf16_f32 v69, v20, v21
  v_lshlrev_b32 v20, 16, v78
  v_and_b32 v21, 0xffff0000, v78
  v_mul_f32 v20, v20, v56
  v_mul_f32 v21, v21, v56
  v_add_u32 v20, 0x10000, v20
  v_and_b32 v20, 0xfffe0000, v20
  v_cvt_pk_bf16_f32 v70, v20, v21
  v_lshlrev_b32 v20, 16, v79
  v_and_b32 v21, 0xffff0000, v79
  v_mul_f32 v20, v20, v56
  v_mul_f32 v21, v21, v56
  v_cvt_pk_bf16_f32 v71, v20, v21
  global_store_dwordx2 v6, v[64:65], s[28:29] offset:1024 sc1
  global_store_dwordx2 v7, v[66:67], s[28:29] offset:1024 sc1
  global_store_dwordx2 v17, v[68:69], s[28:29] offset:1024 sc1
  global_store_dwordx2 v18, v[70:71], s[28:29] offset:1024 sc1
  global_store_dwordx2 v6, v[72:73], s[26:27] offset:1024 sc1
  global_store_dwordx2 v7, v[74:75], s[26:27] offset:1024 sc1
  global_store_dwordx2 v17, v[76:77], s[26:27] offset:1024 sc1
  global_store_dwordx2 v18, v[78:79], s[26:27] offset:1024 sc1
  s_endpgm
k1_w:
  v_cmp_gt_u32 vcc, 512, v0
  s_cbranch_vccz k2_end
  s_load_dwordx8 s[16:23], s[0:1], 32
  s_load_dwordx2 s[24:25], s[0:1], 64
  s_load_dwordx2 s[26:27], s[0:1], 88
  v_lshlrev_b32 v1, 4, v0
  v_bfe_u32 v2, v0, 4, 2
  v_lshrrev_b32 v3, 6, v0
  v_lshl_add_u32 v2, v2, 4, v3
  v_and_b32 v3, 15, v0
  v_mul_u32_u24 v2, 272, v2
  v_lshl_add_u32 v2, v3, 4, v2
  v_add_u32 v4, 0x2000, v1
  v_add_u32 v5, 0x4000, v1
  v_add_u32 v6, 0x6000, v1
  s_waitcnt lgkmcnt(0)
  s_cmp_eq_u32 s2, 0
  s_cselect_b64 s[28:29], s[16:17], s[20:21]
  s_cselect_b64 s[30:31], s[18:19], s[22:23]
  global_load_dwordx4 v[8:11], v1, s[28:29]
  global_load_dwordx4 v[12:15], v4, s[28:29]
  global_load_dwordx4 v[16:19], v5, s[28:29]
  global_load_dwordx4 v[20:23], v6, s[28:29]
  global_load_dwordx4 v[24:27], v1, s[30:31]
  global_load_dwordx4 v[28:31], v4, s[30:31]
  global_load_dwordx4 v[32:35], v5, s[30:31]
  global_load_dwordx4 v[36:39], v6, s[30:31]
  s_waitcnt vmcnt(7)
  ds_write_b128 v2, v[8:11] offset:0
  s_waitcnt vmcnt(6)
  ds_write_b128 v2, v[12:15] offset:2176
  s_waitcnt vmcnt(5)
  ds_write_b128 v2, v[16:19] offset:17408
  s_waitcnt vmcnt(4)
  ds_write_b128 v2, v[20:23] offset:19584
  s_waitcnt vmcnt(3)
  ds_write_b128 v2, v[24:27] offset:34816
  s_waitcnt vmcnt(2)
  ds_write_b128 v2, v[28:31] offset:36992
  s_waitcnt vmcnt(1)
  ds_write_b128 v2, v[32:35] offset:52224
  s_waitcnt vmcnt(0)
  ds_write_b128 v2, v[36:39] offset:54400
  v_lshrrev_b32 v7, 6, v0
  v_and_b32 v1, 63, v0
  v_readfirstlane_b32 s3, v7
  v_bfe_u32 v4, v0, 4, 2
  v_mul_u32_u24 v5, 272, v3
  v_lshl_add_u32 v6, v4, 4, v5
  v_lshl_add_u32 v7, v4, 3, v5
  s_waitcnt lgkmcnt(0)
  s_barrier
  s_cmp_eq_u32 s2, 2
  s_cbranch_scc1 k1_wx
  s_cmp_eq_u32 s2, 1
  s_cbranch_scc1 k1_wv
  s_mul_i32 s4, s3, 4352
  v_add_u32 v2, s4, v6
  ds_read_b128 v[8:11], v2 offset:34816
  ds_read_b128 v[24:27], v2 offset:0
  ds_read_b128 v[12:15], v2 offset:34880
  ds_read_b128 v[28:31], v2 offset:64
  ds_read_b128 v[16:19], v2 offset:34944
  ds_read_b128 v[32:35], v2 offset:128
  ds_read_b128 v[20:23], v2 offset:35008
  ds_read_b128 v[36:39], v2 offset:192
  ds_read_b128 v[40:43], v6 offset:34816
  ds_read_b128 v[44:47], v6 offset:34880
  ds_read_b128 v[48:51], v6 offset:34944
  ds_read_b128 v[52:55], v6 offset:35008
  s_waitcnt lgkmcnt(0)
  v_mfma_f32_16x16x32_bf16 v[96:99], v[40:43], v[24:27], 0
  v_mfma_f32_16x16x32_bf16 v[96:99], v[44:47], v[28:31], v[96:99]
  v_mfma_f32_16x16x32_bf16 v[96:99], v[48:51], v[32:35], v[96:99]
  v_mfma_f32_16x16x32_bf16 v[96:99], v[52:55], v[36:39], v[96:99]
  ds_read_b128 v[100:103], v6 offset:39168
  ds_read_b128 v[104:107], v6 offset:39232
  ds_read_b128 v[108:111], v6 offset:39296
  ds_read_b128 v[112:115], v6 offset:39360
  s_waitcnt lgkmcnt(0)
  v_mfma_f32_16x16x32_bf16 v[96:99], v[100:103], v[24:27], v[96:99]
  v_mfma_f32_16x16x32_bf16 v[96:99], v[104:107], v[28:31], v[96:99]
  v_mfma_f32_16x16x32_bf16 v[96:99], v[108:111], v[32:35], v[96:99]
  v_mfma_f32_16x16x32_bf16 v[96:99], v[112:115], v[36:39], v[96:99]
  ds_read_b128 v[40:43], v6 offset:43520
  ds_read_b128 v[44:47], v6 offset:43584
  ds_read_b128 v[48:51], v6 offset:43648
  ds_read_b128 v[52:55], v6 offset:43712
  s_waitcnt lgkmcnt(0)
  v_mfma_f32_16x16x32_bf16 v[96:99], v[40:43], v[24:27], v[96:99]
  v_mfma_f32_16x16x32_bf16 v[96:99], v[44:47], v[28:31], v[96:99]
  v_mfma_f32_16x16x32_bf16 v[96:99], v[48:51], v[32:35], v[96:99]
  v_mfma_f32_16x16x32_bf16 v[96:99], v[52:55], v[36:39], v[96:99]
  ds_read_b128 v[100:103], v6 offset:47872
  ds_read_b128 v[104:107], v6 offset:47936
  ds_read_b128 v[108:111], v6 offset:48000
  ds_read_b128 v[112:115], v6 offset:48064
  s_waitcnt lgkmcnt(0)
  v_mfma_f32_16x16x32_bf16 v[96:99], v[100:103], v[24:27], v[96:99]
  v_mfma_f32_16x16x32_bf16 v[96:99], v[104:107], v[28:31], v[96:99]
  v_mfma_f32_16x16x32_bf16 v[96:99], v[108:111], v[32:35], v[96:99]
  v_mfma_f32_16x16x32_bf16 v[96:99], v[112:115], v[36:39], v[96:99]
  ds_read_b128 v[40:43], v6 offset:52224
  ds_read_b128 v[44:47], v6 offset:52288
  ds_read_b128 v[48:51], v6 offset:52352
  ds_read_b128 v[52:55], v6 offset:52416
  s_waitcnt lgkmcnt(0)
  v_mfma_f32_16x16x32_bf16 v[96:99], v[40:43], v[24:27], v[96:99]
  v_mfma_f32_16x16x32_bf16 v[96:99], v[44:47], v[28:31], v[96:99]
  v_mfma_f32_16x16x32_bf16 v[96:99], v[48:51], v[32:35], v[96:99]
  v_mfma_f32_16x16x32_bf16 v[96:99], v[52:55], v[36:39], v[96:99]
  ds_read_b128 v[100:103], v6 offset:56576
  ds_read_b128 v[104:107], v6 offset:56640
  ds_read_b128 v[108:111], v6 offset:56704
  ds_read_b128 v[112:115], v6 offset:56768
  s_waitcnt lgkmcnt(0)
  v_mfma_f32_16x16x32_bf16 v[96:99], v[100:103], v[24:27], v[96:99]
  v_mfma_f32_16x16x32_bf16 v[96:99], v[104:107], v[28:31], v[96:99]
  v_mfma_f32_16x16x32_bf16 v[96:99], v[108:111], v[32:35], v[96:99]
  v_mfma_f32_16x16x32_bf16 v[96:99], v[112:115], v[36:39], v[96:99]
  ds_read_b128 v[40:43], v6 offset:60928
  ds_read_b128 v[44:47], v6 offset:60992
  ds_read_b128 v[48:51], v6 offset:61056
  ds_read_b128 v[52:55], v6 offset:61120
  s_waitcnt lgkmcnt(0)
  v_mfma_f32_16x16x32_bf16 v[96:99], v[40:43], v[24:27], v[96:99]
  v_mfma_f32_16x16x32_bf16 v[96:99], v[44:47], v[28:31], v[96:99]
  v_mfma_f32_16x16x32_bf16 v[96:99], v[48:51], v[32:35], v[96:99]
  v_mfma_f32_16x16x32_bf16 v[96:99], v[52:55], v[36:39], v[96:99]
  ds_read_b128 v[100:103], v6 offset:65280
  ds_read_b128 v[104:107], v6 offset:65344
  ds_read_b128 v[108:111], v6 offset:65408
  ds_read_b128 v[112:115], v6 offset:65472
  s_waitcnt lgkmcnt(0)
  v_mfma_f32_16x16x32_bf16 v[96:99], v[100:103], v[24:27], v[96:99]
  v_mfma_f32_16x16x32_bf16 v[96:99], v[104:107], v[28:31], v[96:99]
  v_mfma_f32_16x16x32_bf16 v[96:99], v[108:111], v[32:35], v[96:99]
  v_mfma_f32_16x16x32_bf16 v[96:99], v[112:115], v[36:39], v[96:99]
  s_nop 7
  v_add_f32 v96, v96, v97
  v_add_f32 v98, v98, v99
  v_add_f32 v96, v96, v98
  v_mov_b32 v97, v96
  s_nop 1
  v_permlane16_swap_b32 v96, v97
  v_add_f32 v96, v96, v97
  v_mov_b32 v97, v96
  s_nop 1
  v_permlane32_swap_b32 v96, v97
  v_add_f32 v96, v96, v97
  v_lshlrev_b32 v97, 2, v3
  s_lshl_b32 s4, s3, 6
  s_add_u32 s4, s4, 69632
  v_add_u32 v97, s4, v97
  ds_write_b32 v97, v96
  s_branch k1_wmain
k1_wv:
  s_lshr_b32 s4, s3, 2
  s_lshl_b32 s4, s4, 7
  s_and_b32 s5, s3, 3
  s_lshl_b32 s5, s5, 1
  s_add_u32 s4, s4, s5
  v_mul_u32_u24 v2, 544, v4
  v_lshl_add_u32 v2, v3, 3, v2
  v_add_u32 v2, s4, v2
  v_add_u32 v2, 34816, v2
  ds_read_u16 v40, v2 offset:0
  ds_read_u16 v100, v2 offset:4352
  ds_read_u16 v41, v2 offset:8704
  ds_read_u16 v101, v2 offset:13056
  ds_read_u16 v42, v2 offset:272
  ds_read_u16 v102, v2 offset:4624
  ds_read_u16 v43, v2 offset:8976
  ds_read_u16 v103, v2 offset:13328
  ds_read_u16 v44, v2 offset:2176
  ds_read_u16 v104, v2 offset:6528
  ds_read_u16 v45, v2 offset:10880
  ds_read_u16 v105, v2 offset:15232
  ds_read_u16 v46, v2 offset:2448
  ds_read_u16 v106, v2 offset:6800
  ds_read_u16 v47, v2 offset:11152
  ds_read_u16 v107, v2 offset:15504
  ds_read_u16 v48, v2 offset:17408
  ds_read_u16 v108, v2 offset:21760
  ds_read_u16 v49, v2 offset:26112
  ds_read_u16 v109, v2 offset:30464
  ds_read_u16 v50, v2 offset:17680
  ds_read_u16 v110, v2 offset:22032
  ds_read_u16 v51, v2 offset:26384
  ds_read_u16 v111, v2 offset:30736
  ds_read_u16 v52, v2 offset:19584
  ds_read_u16 v112, v2 offset:23936
  ds_read_u16 v53, v2 offset:28288
  ds_read_u16 v113, v2 offset:32640
  ds_read_u16 v54, v2 offset:19856
  ds_read_u16 v114, v2 offset:24208
  ds_read_u16 v55, v2 offset:28560
  ds_read_u16 v115, v2 offset:32912
  s_waitcnt lgkmcnt(0)
  v_lshl_or_b32 v8, v100, 16, v40
  v_lshl_or_b32 v9, v101, 16, v41
  v_lshl_or_b32 v10, v102, 16, v42
  v_lshl_or_b32 v11, v103, 16, v43
  v_lshl_or_b32 v12, v104, 16, v44
  v_lshl_or_b32 v13, v105, 16, v45
  v_lshl_or_b32 v14, v106, 16, v46
  v_lshl_or_b32 v15, v107, 16, v47
  v_lshl_or_b32 v16, v108, 16, v48
  v_lshl_or_b32 v17, v109, 16, v49
  v_lshl_or_b32 v18, v110, 16, v50
  v_lshl_or_b32 v19, v111, 16, v51
  v_lshl_or_b32 v20, v112, 16, v52
  v_lshl_or_b32 v21, v113, 16, v53
  v_lshl_or_b32 v22, v114, 16, v54
  v_lshl_or_b32 v23, v115, 16, v55
k1_wmain:
  ds_read_b128 v[40:43], v6 offset:0
  ds_read_b128 v[44:47], v6 offset:64
  ds_read_b128 v[48:51], v6 offset:128
  ds_read_b128 v[52:55], v6 offset:192
  s_waitcnt lgkmcnt(0)
  v_mfma_f32_16x16x32_bf16 v[64:67], v[40:43], v[8:11], 0
  v_mfma_f32_16x16x32_bf16 v[64:67], v[44:47], v[12:15], v[64:67]
  v_mfma_f32_16x16x32_bf16 v[64:67], v[48:51], v[16:19], v[64:67]
  v_mfma_f32_16x16x32_bf16 v[64:67], v[52:55], v[20:23], v[64:67]
  ds_read_b128 v[100:103], v6 offset:4352
  ds_read_b128 v[104:107], v6 offset:4416
  ds_read_b128 v[108:111], v6 offset:4480
  ds_read_b128 v[112:115], v6 offset:4544
  s_waitcnt lgkmcnt(0)
  v_mfma_f32_16x16x32_bf16 v[68:71], v[100:103], v[8:11], 0
  v_mfma_f32_16x16x32_bf16 v[68:71], v[104:107], v[12:15], v[68:71]
  v_mfma_f32_16x16x32_bf16 v[68:71], v[108:111], v[16:19], v[68:71]
  v_mfma_f32_16x16x32_bf16 v[68:71], v[112:115], v[20:23], v[68:71]
  ds_read_b128 v[40:43], v6 offset:8704
  ds_read_b128 v[44:47], v6 offset:8768
  ds_read_b128 v[48:51], v6 offset:8832
  ds_read_b128 v[52:55], v6 offset:8896
  s_waitcnt lgkmcnt(0)
  v_mfma_f32_16x16x32_bf16 v[72:75], v[40:43], v[8:11], 0
  v_mfma_f32_16x16x32_bf16 v[72:75], v[44:47], v[12:15], v[72:75]
  v_mfma_f32_16x16x32_bf16 v[72:75], v[48:51], v[16:19], v[72:75]
  v_mfma_f32_16x16x32_bf16 v[72:75], v[52:55], v[20:23], v[72:75]
  ds_read_b128 v[100:103], v6 offset:13056
  ds_read_b128 v[104:107], v6 offset:13120
  ds_read_b128 v[108:111], v6 offset:13184
  ds_read_b128 v[112:115], v6 offset:13248
  s_waitcnt lgkmcnt(0)
  v_mfma_f32_16x16x32_bf16 v[76:79], v[100:103], v[8:11], 0
  v_mfma_f32_16x16x32_bf16 v[76:79], v[104:107], v[12:15], v[76:79]
  v_mfma_f32_16x16x32_bf16 v[76:79], v[108:111], v[16:19], v[76:79]
  v_mfma_f32_16x16x32_bf16 v[76:79], v[112:115], v[20:23], v[76:79]
  ds_read_b128 v[40:43], v6 offset:17408
  ds_read_b128 v[44:47], v6 offset:17472
  ds_read_b128 v[48:51], v6 offset:17536
  ds_read_b128 v[52:55], v6 offset:17600
  s_waitcnt lgkmcnt(0)
  v_mfma_f32_16x16x32_bf16 v[80:83], v[40:43], v[8:11], 0
  v_mfma_f32_16x16x32_bf16 v[80:83], v[44:47], v[12:15], v[80:83]
  v_mfma_f32_16x16x32_bf16 v[80:83], v[48:51], v[16:19], v[80:83]
  v_mfma_f32_16x16x32_bf16 v[80:83], v[52:55], v[20:23], v[80:83]
  ds_read_b128 v[100:103], v6 offset:21760
  ds_read_b128 v[104:107], v6 offset:21824
  ds_read_b128 v[108:111], v6 offset:21888
  ds_read_b128 v[112:115], v6 offset:21952
  s_waitcnt lgkmcnt(0)
  v_mfma_f32_16x16x32_bf16 v[84:87], v[100:103], v[8:11], 0
  v_mfma_f32_16x16x32_bf16 v[84:87], v[104:107], v[12:15], v[84:87]
  v_mfma_f32_16x16x32_bf16 v[84:87], v[108:111], v[16:19], v[84:87]
  v_mfma_f32_16x16x32_bf16 v[84:87], v[112:115], v[20:23], v[84:87]
  ds_read_b128 v[40:43], v6 offset:26112
  ds_read_b128 v[44:47], v6 offset:26176
  ds_read_b128 v[48:51], v6 offset:26240
  ds_read_b128 v[52:55], v6 offset:26304
  s_waitcnt lgkmcnt(0)
  v_mfma_f32_16x16x32_bf16 v[88:91], v[40:43], v[8:11], 0
  v_mfma_f32_16x16x32_bf16 v[88:91], v[44:47], v[12:15], v[88:91]
  v_mfma_f32_16x16x32_bf16 v[88:91], v[48:51], v[16:19], v[88:91]
  v_mfma_f32_16x16x32_bf16 v[88:91], v[52:55], v[20:23], v[88:91]
  ds_read_b128 v[100:103], v6 offset:30464
  ds_read_b128 v[104:107], v6 offset:30528
  ds_read_b128 v[108:111], v6 offset:30592
  ds_read_b128 v[112:115], v6 offset:30656
  s_waitcnt lgkmcnt(0)
  v_mfma_f32_16x16x32_bf16 v[92:95], v[100:103], v[8:11], 0
  v_mfma_f32_16x16x32_bf16 v[92:95], v[104:107], v[12:15], v[92:95]
  v_mfma_f32_16x16x32_bf16 v[92:95], v[108:111], v[16:19], v[92:95]
  v_mfma_f32_16x16x32_bf16 v[92:95], v[112:115], v[20:23], v[92:95]
  s_lshl_b32 s4, s3, 12
  s_lshl_b32 s5, s2, 15
  s_add_u32 s4, s4, s5
  s_add_u32 s4, s4, 56446976
  v_lshl_add_u32 v2, v1, 4, s4
  v_mov_b32 v9, 1.0
  s_cmp_eq_u32 s2, 1
  s_cbranch_scc1 k1_wfin
  s_barrier
  v_lshlrev_b32 v8, 4, v4
  v_add_u32 v8, 69632, v8
  ds_read_b128 v[12:15], v8 offset:0
  ds_read_b128 v[16:19], v8 offset:64
  ds_read_b128 v[20:23], v8 offset:128
  ds_read_b128 v[24:27], v8 offset:192
  ds_read_b128 v[28:31], v8 offset:256
  ds_read_b128 v[32:35], v8 offset:320
  ds_read_b128 v[36:39], v8 offset:384
  ds_read_b128 v[40:43], v8 offset:448
  v_mov_b32 v9, 0x3e0293ee
  v_mov_b32 v10, 0xbc000000
  s_waitcnt lgkmcnt(0)
  v_fmac_f32 v64, v12, v10
  v_fmac_f32 v65, v13, v10
  v_fmac_f32 v66, v14, v10
  v_fmac_f32 v67, v15, v10
  v_fmac_f32 v68, v16, v10
  v_fmac_f32 v69, v17, v10
  v_fmac_f32 v70, v18, v10
  v_fmac_f32 v71, v19, v10
  v_fmac_f32 v72, v20, v10
  v_fmac_f32 v73, v21, v10
  v_fmac_f32 v74, v22, v10
  v_fmac_f32 v75, v23, v10
  v_fmac_f32 v76, v24, v10
  v_fmac_f32 v77, v25, v10
  v_fmac_f32 v78, v26, v10
  v_fmac_f32 v79, v27, v10
  v_fmac_f32 v80, v28, v10
  v_fmac_f32 v81, v29, v10
  v_fmac_f32 v82, v30, v10
  v_fmac_f32 v83, v31, v10
  v_fmac_f32 v84, v32, v10
  v_fmac_f32 v85, v33, v10
  v_fmac_f32 v86, v34, v10
  v_fmac_f32 v87, v35, v10
  v_fmac_f32 v88, v36, v10
  v_fmac_f32 v89, v37, v10
  v_fmac_f32 v90, v38, v10
  v_fmac_f32 v91, v39, v10
  v_fmac_f32 v92, v40, v10
  v_fmac_f32 v93, v41, v10
  v_fmac_f32 v94, v42, v10
  v_fmac_f32 v95, v43, v10
k1_wfin:
  v_add_f32 v10, v64, v65
  v_add_f32 v10, v10, v66
  v_add_f32 v10, v10, v67
  v_add_f32 v10, v10, v68
  v_add_f32 v10, v10, v69
  v_add_f32 v10, v10, v70
  v_add_f32 v10, v10, v71
  v_add_f32 v10, v10, v72
  v_add_f32 v10, v10, v73
  v_add_f32 v10, v10, v74
  v_add_f32 v10, v10, v75
  v_add_f32 v10, v10, v76
  v_add_f32 v10, v10, v77
  v_add_f32 v10, v10, v78
  v_add_f32 v10, v10, v79
  v_add_f32 v10, v10, v80
  v_add_f32 v10, v10, v81
  v_add_f32 v10, v10, v82
  v_add_f32 v10, v10, v83
  v_add_f32 v10, v10, v84
  v_add_f32 v10, v10, v85
  v_add_f32 v10, v10, v86
  v_add_f32 v10, v10, v87
  v_add_f32 v10, v10, v88
  v_add_f32 v10, v10, v89
  v_add_f32 v10, v10, v90
  v_add_f32 v10, v10, v91
  v_add_f32 v10, v10, v92
  v_add_f32 v10, v10, v93
  v_add_f32 v10, v10, v94
  v_add_f32 v10, v10, v95
  v_mov_b32 v11, v10
  s_nop 1
  v_permlane16_swap_b32 v10, v11
  v_add_f32 v10, v10, v11
  v_mov_b32 v11, v10
  s_nop 1
  v_permlane32_swap_b32 v10, v11
  v_add_f32 v10, v10, v11
  v_mul_f32 v10, 0xbc000000, v10
  v_add_f32 v64, v64, v10
  v_mul_f32 v64, v64, v9
  v_add_f32 v65, v65, v10
  v_mul_f32 v65, v65, v9
  v_add_f32 v66, v66, v10
  v_mul_f32 v66, v66, v9
  v_add_f32 v67, v67, v10
  v_mul_f32 v67, v67, v9
  v_add_f32 v68, v68, v10
  v_mul_f32 v68, v68, v9
  v_add_f32 v69, v69, v10
  v_mul_f32 v69, v69, v9
  v_add_f32 v70, v70, v10
  v_mul_f32 v70, v70, v9
  v_add_f32 v71, v71, v10
  v_mul_f32 v71, v71, v9
  v_add_f32 v72, v72, v10
  v_mul_f32 v72, v72, v9
  v_add_f32 v73, v73, v10
  v_mul_f32 v73, v73, v9
  v_add_f32 v74, v74, v10
  v_mul_f32 v74, v74, v9
  v_add_f32 v75, v75, v10
  v_mul_f32 v75, v75, v9
  v_add_f32 v76, v76, v10
  v_mul_f32 v76, v76, v9
  v_add_f32 v77, v77, v10
  v_mul_f32 v77, v77, v9
  v_add_f32 v78, v78, v10
  v_mul_f32 v78, v78, v9
  v_add_f32 v79, v79, v10
  v_mul_f32 v79, v79, v9
  v_add_f32 v80, v80, v10
  v_mul_f32 v80, v80, v9
  v_add_f32 v81, v81, v10
  v_mul_f32 v81, v81, v9
  v_add_f32 v82, v82, v10
  v_mul_f32 v82, v82, v9
  v_add_f32 v83, v83, v10
  v_mul_f32 v83, v83, v9
  v_add_f32 v84, v84, v10
  v_mul_f32 v84, v84, v9
  v_add_f32 v85, v85, v10
  v_mul_f32 v85, v85, v9
  v_add_f32 v86, v86, v10
  v_mul_f32 v86, v86, v9
  v_add_f32 v87, v87, v10
  v_mul_f32 v87, v87, v9
  v_add_f32 v88, v88, v10
  v_mul_f32 v88, v88, v9
  v_add_f32 v89, v89, v10
  v_mul_f32 v89, v89, v9
  v_add_f32 v90, v90, v10
  v_mul_f32 v90, v90, v9
  v_add_f32 v91, v91, v10
  v_mul_f32 v91, v91, v9
  v_add_f32 v92, v92, v10
  v_mul_f32 v92, v92, v9
  v_add_f32 v93, v93, v10
  v_mul_f32 v93, v93, v9
  v_add_f32 v94, v94, v10
  v_mul_f32 v94, v94, v9
  v_add_f32 v95, v95, v10
  v_mul_f32 v95, v95, v9
  v_cvt_pk_bf16_f32 v12, v64, v65
  v_cvt_pk_bf16_f32 v13, v66, v67
  v_cvt_pk_bf16_f32 v14, v68, v69
  v_cvt_pk_bf16_f32 v15, v70, v71
  global_store_dwordx4 v2, v[12:15], s[26:27] offset:0
  v_cvt_pk_bf16_f32 v16, v72, v73
  v_cvt_pk_bf16_f32 v17, v74, v75
  v_cvt_pk_bf16_f32 v18, v76, v77
  v_cvt_pk_bf16_f32 v19, v78, v79
  global_store_dwordx4 v2, v[16:19], s[26:27] offset:1024
  v_cvt_pk_bf16_f32 v20, v80, v81
  v_cvt_pk_bf16_f32 v21, v82, v83
  v_cvt_pk_bf16_f32 v22, v84, v85
  v_cvt_pk_bf16_f32 v23, v86, v87
  global_store_dwordx4 v2, v[20:23], s[26:27] offset:2048
  v_cvt_pk_bf16_f32 v24, v88, v89
  v_cvt_pk_bf16_f32 v25, v90, v91
  v_cvt_pk_bf16_f32 v26, v92, v93
  v_cvt_pk_bf16_f32 v27, v94, v95
  global_store_dwordx4 v2, v[24:27], s[26:27] offset:3072
  s_endpgm
k1_wx:
  s_cmp_lt_u32 s3, 4
  s_cbranch_scc1 k1_wx0
  v_and_b32 v8, 255, v0
  v_lshlrev_b32 v8, 7, v8
  v_add_u32 v8, 56520960, v8
  v_mov_b32 v9, 0
  global_store_dword v8, v9, s[26:27]
  s_endpgm
k1_wx0:
  s_cmp_lg_u32 s3, 0
  s_cbranch_scc1 k2_end
  v_lshlrev_b32 v2, 5, v4
  global_load_dwordx4 v[8:11], v2, s[24:25] offset:0
  global_load_dwordx4 v[12:15], v2, s[24:25] offset:16
  global_load_dwordx4 v[16:19], v2, s[24:25] offset:128
  global_load_dwordx4 v[20:23], v2, s[24:25] offset:144
  s_mov_b32 s4, 0x05040100
  s_mov_b32 s5, 0x07060302
  v_mov_b32 v25, 0x3c003c00
  v_and_b32 v24, 7, v0
  v_cmp_eq_u32 s[28:29], 2, v24
  v_cmp_gt_u32 vcc, 2, v24
  v_cmp_eq_u32 s[30:31], 4, v24
  s_or_b64 vcc, vcc, s[30:31]
  v_cndmask_b32 v29, 0, v25, vcc
  v_cmp_lt_u32 vcc, 3, v24
  v_and_b32 v24, 3, v0
  v_cmp_eq_u32 s[30:31], 3, v24
  v_mov_b32 v26, 0
  v_lshrrev_b32 v30, 2, v3
  v_lshl_add_u32 v30, v24, 4, v30
  v_mul_u32_u24 v30, 272, v30
  v_lshl_add_u32 v30, v4, 5, v30
  s_waitcnt vmcnt(0)
  v_perm_b32 v64, v10, v8, s4
  v_cndmask_b32 v64, v29, v64, s[28:29]
  v_perm_b32 v65, v14, v12, s4
  v_cndmask_b32 v65, v29, v65, s[28:29]
  v_perm_b32 v66, v10, v8, s5
  v_cndmask_b32 v66, v29, v66, s[28:29]
  v_perm_b32 v67, v14, v12, s5
  v_cndmask_b32 v67, v29, v67, s[28:29]
  v_perm_b32 v68, v11, v9, s4
  v_cndmask_b32 v68, v29, v68, s[28:29]
  v_perm_b32 v69, v15, v13, s4
  v_cndmask_b32 v69, v29, v69, s[28:29]
  v_perm_b32 v70, v11, v9, s5
  v_cndmask_b32 v70, v29, v70, s[28:29]
  v_perm_b32 v71, v15, v13, s5
  v_cndmask_b32 v71, v29, v71, s[28:29]
  v_perm_b32 v72, v18, v16, s4
  v_cndmask_b32 v72, v29, v72, s[28:29]
  v_perm_b32 v73, v22, v20, s4
  v_cndmask_b32 v73, v29, v73, s[28:29]
  v_perm_b32 v74, v18, v16, s5
  v_cndmask_b32 v74, v29, v74, s[28:29]
  v_perm_b32 v75, v22, v20, s5
  v_cndmask_b32 v75, v29, v75, s[28:29]
  v_perm_b32 v76, v19, v17, s4
  v_cndmask_b32 v76, v29, v76, s[28:29]
  v_perm_b32 v77, v23, v21, s4
  v_cndmask_b32 v77, v29, v77, s[28:29]
  v_perm_b32 v78, v19, v17, s5
  v_cndmask_b32 v78, v29, v78, s[28:29]
  v_perm_b32 v79, v23, v21, s5
  v_cndmask_b32 v79, v29, v79, s[28:29]
  v_lshlrev_b32 v27, 16, v8
  v_and_b32 v28, 0xffff0000, v8
  v_add_f32 v26, v26, v27
  v_add_f32 v26, v26, v28
  v_cndmask_b32 v8, v25, v8, vcc
  v_lshlrev_b32 v27, 16, v9
  v_and_b32 v28, 0xffff0000, v9
  v_add_f32 v26, v26, v27
  v_add_f32 v26, v26, v28
  v_cndmask_b32 v9, v25, v9, vcc
  v_lshlrev_b32 v27, 16, v10
  v_and_b32 v28, 0xffff0000, v10
  v_add_f32 v26, v26, v27
  v_add_f32 v26, v26, v28
  v_cndmask_b32 v10, v25, v10, vcc
  v_lshlrev_b32 v27, 16, v11
  v_and_b32 v28, 0xffff0000, v11
  v_add_f32 v26, v26, v27
  v_add_f32 v26, v26, v28
  v_cndmask_b32 v11, v25, v11, vcc
  v_lshlrev_b32 v27, 16, v12
  v_and_b32 v28, 0xffff0000, v12
  v_add_f32 v26, v26, v27
  v_add_f32 v26, v26, v28
  v_cndmask_b32 v12, v25, v12, vcc
  v_lshlrev_b32 v27, 16, v13
  v_and_b32 v28, 0xffff0000, v13
  v_add_f32 v26, v26, v27
  v_add_f32 v26, v26, v28
  v_cndmask_b32 v13, v25, v13, vcc
  v_lshlrev_b32 v27, 16, v14
  v_and_b32 v28, 0xffff0000, v14
  v_add_f32 v26, v26, v27
  v_add_f32 v26, v26, v28
  v_cndmask_b32 v14, v25, v14, vcc
  v_lshlrev_b32 v27, 16, v15
  v_and_b32 v28, 0xffff0000, v15
  v_add_f32 v26, v26, v27
  v_add_f32 v26, v26, v28
  v_cndmask_b32 v15, v25, v15, vcc
  v_lshlrev_b32 v27, 16, v16
  v_and_b32 v28, 0xffff0000, v16
  v_add_f32 v26, v26, v27
  v_add_f32 v26, v26, v28
  v_cndmask_b32 v16, v25, v16, vcc
  v_lshlrev_b32 v27, 16, v17
  v_and_b32 v28, 0xffff0000, v17
  v_add_f32 v26, v26, v27
  v_add_f32 v26, v26, v28
  v_cndmask_b32 v17, v25, v17, vcc
  v_lshlrev_b32 v27, 16, v18
  v_and_b32 v28, 0xffff0000, v18
  v_add_f32 v26, v26, v27
  v_add_f32 v26, v26, v28
  v_cndmask_b32 v18, v25, v18, vcc
  v_lshlrev_b32 v27, 16, v19
  v_and_b32 v28, 0xffff0000, v19
  v_add_f32 v26, v26, v27
  v_add_f32 v26, v26, v28
  v_cndmask_b32 v19, v25, v19, vcc
  v_lshlrev_b32 v27, 16, v20
  v_and_b32 v28, 0xffff0000, v20
  v_add_f32 v26, v26, v27
  v_add_f32 v26, v26, v28
  v_cndmask_b32 v20, v25, v20, vcc
  v_lshlrev_b32 v27, 16, v21
  v_and_b32 v28, 0xffff0000, v21
  v_add_f32 v26, v26, v27
  v_add_f32 v26, v26, v28
  v_cndmask_b32 v21, v25, v21, vcc
  v_lshlrev_b32 v27, 16, v22
  v_and_b32 v28, 0xffff0000, v22
  v_add_f32 v26, v26, v27
  v_add_f32 v26, v26, v28
  v_cndmask_b32 v22, v25, v22, vcc
  v_lshlrev_b32 v27, 16, v23
  v_and_b32 v28, 0xffff0000, v23
  v_add_f32 v26, v26, v27
  v_add_f32 v26, v26, v28
  v_cndmask_b32 v23, v25, v23, vcc
  v_mov_b32 v27, v26
  s_nop 1
  v_permlane16_swap_b32 v26, v27
  v_add_f32 v26, v26, v27
  v_mov_b32 v27, v26
  s_nop 1
  v_permlane32_swap_b32 v26, v27
  v_add_f32 v26, v26, v27
  v_lshlrev_b32 v2, 4, v1
  v_add_u32 v2, 56512512, v2
  v_mov_b32 v28, 56520704
  global_store_dword v28, v26, s[26:27]
  s_not_b64 exec, s[30:31]
  global_store_dwordx4 v2, v[64:67], s[26:27] offset:0
  global_store_dwordx4 v2, v[68:71], s[26:27] offset:1024
  global_store_dwordx4 v2, v[72:75], s[26:27] offset:2048
  global_store_dwordx4 v2, v[76:79], s[26:27] offset:3072
  s_mov_b64 exec, -1
  s_waitcnt vmcnt(0)
  ds_read_b128 v[40:43], v30 offset:34816
  ds_read_b128 v[44:47], v30 offset:34832
  ds_read_b128 v[48:51], v30 offset:34944
  ds_read_b128 v[52:55], v30 offset:34960
  s_waitcnt lgkmcnt(0)
  v_mfma_f32_16x16x32_bf16 v[64:67], v[40:43], v[8:11], 0
  v_mfma_f32_16x16x32_bf16 v[64:67], v[44:47], v[12:15], v[64:67]
  v_mfma_f32_16x16x32_bf16 v[64:67], v[48:51], v[16:19], v[64:67]
  v_mfma_f32_16x16x32_bf16 v[64:67], v[52:55], v[20:23], v[64:67]
  ds_read_b128 v[100:103], v30 offset:35904
  ds_read_b128 v[104:107], v30 offset:35920
  ds_read_b128 v[108:111], v30 offset:36032
  ds_read_b128 v[112:115], v30 offset:36048
  s_waitcnt lgkmcnt(0)
  v_mfma_f32_16x16x32_bf16 v[68:71], v[100:103], v[8:11], 0
  v_mfma_f32_16x16x32_bf16 v[68:71], v[104:107], v[12:15], v[68:71]
  v_mfma_f32_16x16x32_bf16 v[68:71], v[108:111], v[16:19], v[68:71]
  v_mfma_f32_16x16x32_bf16 v[68:71], v[112:115], v[20:23], v[68:71]
  ds_read_b128 v[40:43], v30 offset:36992
  ds_read_b128 v[44:47], v30 offset:37008
  ds_read_b128 v[48:51], v30 offset:37120
  ds_read_b128 v[52:55], v30 offset:37136
  s_waitcnt lgkmcnt(0)
  v_mfma_f32_16x16x32_bf16 v[72:75], v[40:43], v[8:11], 0
  v_mfma_f32_16x16x32_bf16 v[72:75], v[44:47], v[12:15], v[72:75]
  v_mfma_f32_16x16x32_bf16 v[72:75], v[48:51], v[16:19], v[72:75]
  v_mfma_f32_16x16x32_bf16 v[72:75], v[52:55], v[20:23], v[72:75]
  ds_read_b128 v[100:103], v30 offset:38080
  ds_read_b128 v[104:107], v30 offset:38096
  ds_read_b128 v[108:111], v30 offset:38208
  ds_read_b128 v[112:115], v30 offset:38224
  s_waitcnt lgkmcnt(0)
  v_mfma_f32_16x16x32_bf16 v[76:79], v[100:103], v[8:11], 0
  v_mfma_f32_16x16x32_bf16 v[76:79], v[104:107], v[12:15], v[76:79]
  v_mfma_f32_16x16x32_bf16 v[76:79], v[108:111], v[16:19], v[76:79]
  v_mfma_f32_16x16x32_bf16 v[76:79], v[112:115], v[20:23], v[76:79]
  ds_read_b128 v[40:43], v30 offset:52224
  ds_read_b128 v[44:47], v30 offset:52240
  ds_read_b128 v[48:51], v30 offset:52352
  ds_read_b128 v[52:55], v30 offset:52368
  s_waitcnt lgkmcnt(0)
  v_mfma_f32_16x16x32_bf16 v[80:83], v[40:43], v[8:11], 0
  v_mfma_f32_16x16x32_bf16 v[80:83], v[44:47], v[12:15], v[80:83]
  v_mfma_f32_16x16x32_bf16 v[80:83], v[48:51], v[16:19], v[80:83]
  v_mfma_f32_16x16x32_bf16 v[80:83], v[52:55], v[20:23], v[80:83]
  ds_read_b128 v[100:103], v30 offset:53312
  ds_read_b128 v[104:107], v30 offset:53328
  ds_read_b128 v[108:111], v30 offset:53440
  ds_read_b128 v[112:115], v30 offset:53456
  s_waitcnt lgkmcnt(0)
  v_mfma_f32_16x16x32_bf16 v[84:87], v[100:103], v[8:11], 0
  v_mfma_f32_16x16x32_bf16 v[84:87], v[104:107], v[12:15], v[84:87]
  v_mfma_f32_16x16x32_bf16 v[84:87], v[108:111], v[16:19], v[84:87]
  v_mfma_f32_16x16x32_bf16 v[84:87], v[112:115], v[20:23], v[84:87]
  ds_read_b128 v[40:43], v30 offset:54400
  ds_read_b128 v[44:47], v30 offset:54416
  ds_read_b128 v[48:51], v30 offset:54528
  ds_read_b128 v[52:55], v30 offset:54544
  s_waitcnt lgkmcnt(0)
  v_mfma_f32_16x16x32_bf16 v[88:91], v[40:43], v[8:11], 0
  v_mfma_f32_16x16x32_bf16 v[88:91], v[44:47], v[12:15], v[88:91]
  v_mfma_f32_16x16x32_bf16 v[88:91], v[48:51], v[16:19], v[88:91]
  v_mfma_f32_16x16x32_bf16 v[88:91], v[52:55], v[20:23], v[88:91]
  ds_read_b128 v[100:103], v30 offset:55488
  ds_read_b128 v[104:107], v30 offset:55504
  ds_read_b128 v[108:111], v30 offset:55616
  ds_read_b128 v[112:115], v30 offset:55632
  s_waitcnt lgkmcnt(0)
  v_mfma_f32_16x16x32_bf16 v[92:95], v[100:103], v[8:11], 0
  v_mfma_f32_16x16x32_bf16 v[92:95], v[104:107], v[12:15], v[92:95]
  v_mfma_f32_16x16x32_bf16 v[92:95], v[108:111], v[16:19], v[92:95]
  v_mfma_f32_16x16x32_bf16 v[92:95], v[112:115], v[20:23], v[92:95]
  s_waitcnt vmcnt(0)
  v_cvt_pk_bf16_f32 v8, v64, v65
  v_lshlrev_b32 v56, 16, v8
  v_and_b32 v57, 0xffff0000, v8
  v_sub_f32 v56, v64, v56
  v_sub_f32 v57, v65, v57
  v_cvt_pk_bf16_f32 v24, v56, v57
  v_cvt_pk_bf16_f32 v9, v66, v67
  v_lshlrev_b32 v56, 16, v9
  v_and_b32 v57, 0xffff0000, v9
  v_sub_f32 v56, v66, v56
  v_sub_f32 v57, v67, v57
  v_cvt_pk_bf16_f32 v25, v56, v57
  v_cvt_pk_bf16_f32 v10, v68, v69
  v_lshlrev_b32 v56, 16, v10
  v_and_b32 v57, 0xffff0000, v10
  v_sub_f32 v56, v68, v56
  v_sub_f32 v57, v69, v57
  v_cvt_pk_bf16_f32 v26, v56, v57
  v_cvt_pk_bf16_f32 v11, v70, v71
  v_lshlrev_b32 v56, 16, v11
  v_and_b32 v57, 0xffff0000, v11
  v_sub_f32 v56, v70, v56
  v_sub_f32 v57, v71, v57
  v_cvt_pk_bf16_f32 v27, v56, v57
  v_cvt_pk_bf16_f32 v12, v72, v73
  v_lshlrev_b32 v56, 16, v12
  v_and_b32 v57, 0xffff0000, v12
  v_sub_f32 v56, v72, v56
  v_sub_f32 v57, v73, v57
  v_cvt_pk_bf16_f32 v28, v56, v57
  v_cvt_pk_bf16_f32 v13, v74, v75
  v_lshlrev_b32 v56, 16, v13
  v_and_b32 v57, 0xffff0000, v13
  v_sub_f32 v56, v74, v56
  v_sub_f32 v57, v75, v57
  v_cvt_pk_bf16_f32 v29, v56, v57
  v_cvt_pk_bf16_f32 v14, v76, v77
  v_lshlrev_b32 v56, 16, v14
  v_and_b32 v57, 0xffff0000, v14
  v_sub_f32 v56, v76, v56
  v_sub_f32 v57, v77, v57
  v_cvt_pk_bf16_f32 v30, v56, v57
  v_cvt_pk_bf16_f32 v15, v78, v79
  v_lshlrev_b32 v56, 16, v15
  v_and_b32 v57, 0xffff0000, v15
  v_sub_f32 v56, v78, v56
  v_sub_f32 v57, v79, v57
  v_cvt_pk_bf16_f32 v31, v56, v57
  v_cvt_pk_bf16_f32 v16, v80, v81
  v_lshlrev_b32 v56, 16, v16
  v_and_b32 v57, 0xffff0000, v16
  v_sub_f32 v56, v80, v56
  v_sub_f32 v57, v81, v57
  v_cvt_pk_bf16_f32 v32, v56, v57
  v_cvt_pk_bf16_f32 v17, v82, v83
  v_lshlrev_b32 v56, 16, v17
  v_and_b32 v57, 0xffff0000, v17
  v_sub_f32 v56, v82, v56
  v_sub_f32 v57, v83, v57
  v_cvt_pk_bf16_f32 v33, v56, v57
  v_cvt_pk_bf16_f32 v18, v84, v85
  v_lshlrev_b32 v56, 16, v18
  v_and_b32 v57, 0xffff0000, v18
  v_sub_f32 v56, v84, v56
  v_sub_f32 v57, v85, v57
  v_cvt_pk_bf16_f32 v34, v56, v57
  v_cvt_pk_bf16_f32 v19, v86, v87
  v_lshlrev_b32 v56, 16, v19
  v_and_b32 v57, 0xffff0000, v19
  v_sub_f32 v56, v86, v56
  v_sub_f32 v57, v87, v57
  v_cvt_pk_bf16_f32 v35, v56, v57
  v_cvt_pk_bf16_f32 v20, v88, v89
  v_lshlrev_b32 v56, 16, v20
  v_and_b32 v57, 0xffff0000, v20
  v_sub_f32 v56, v88, v56
  v_sub_f32 v57, v89, v57
  v_cvt_pk_bf16_f32 v36, v56, v57
  v_cvt_pk_bf16_f32 v21, v90, v91
  v_lshlrev_b32 v56, 16, v21
  v_and_b32 v57, 0xffff0000, v21
  v_sub_f32 v56, v90, v56
  v_sub_f32 v57, v91, v57
  v_cvt_pk_bf16_f32 v37, v56, v57
  v_cvt_pk_bf16_f32 v22, v92, v93
  v_lshlrev_b32 v56, 16, v22
  v_and_b32 v57, 0xffff0000, v22
  v_sub_f32 v56, v92, v56
  v_sub_f32 v57, v93, v57
  v_cvt_pk_bf16_f32 v38, v56, v57
  v_cvt_pk_bf16_f32 v23, v94, v95
  v_lshlrev_b32 v56, 16, v23
  v_and_b32 v57, 0xffff0000, v23
  v_sub_f32 v56, v94, v56
  v_sub_f32 v57, v95, v57
  v_cvt_pk_bf16_f32 v39, v56, v57
  ds_read_b64 v[40:41], v7 offset:0
  ds_read_b64 v[42:43], v7 offset:32
  ds_read_b64 v[44:45], v7 offset:64
  ds_read_b64 v[46:47], v7 offset:96
  ds_read_b64 v[48:49], v7 offset:128
  ds_read_b64 v[50:51], v7 offset:160
  ds_read_b64 v[52:53], v7 offset:192
  ds_read_b64 v[54:55], v7 offset:224
  s_waitcnt lgkmcnt(0)
  v_mfma_f32_16x16x32_bf16 v[64:67], v[40:43], v[8:11], 0
  v_mfma_f32_16x16x32_bf16 v[64:67], v[40:43], v[24:27], v[64:67]
  v_mfma_f32_16x16x32_bf16 v[64:67], v[44:47], v[12:15], v[64:67]
  v_mfma_f32_16x16x32_bf16 v[64:67], v[44:47], v[28:31], v[64:67]
  v_mfma_f32_16x16x32_bf16 v[64:67], v[48:51], v[16:19], v[64:67]
  v_mfma_f32_16x16x32_bf16 v[64:67], v[48:51], v[32:35], v[64:67]
  v_mfma_f32_16x16x32_bf16 v[64:67], v[52:55], v[20:23], v[64:67]
  v_mfma_f32_16x16x32_bf16 v[64:67], v[52:55], v[36:39], v[64:67]
  ds_read_b64 v[100:101], v7 offset:4352
  ds_read_b64 v[102:103], v7 offset:4384
  ds_read_b64 v[104:105], v7 offset:4416
  ds_read_b64 v[106:107], v7 offset:4448
  ds_read_b64 v[108:109], v7 offset:4480
  ds_read_b64 v[110:111], v7 offset:4512
  ds_read_b64 v[112:113], v7 offset:4544
  ds_read_b64 v[114:115], v7 offset:4576
  s_waitcnt lgkmcnt(0)
  v_mfma_f32_16x16x32_bf16 v[68:71], v[100:103], v[8:11], 0
  v_mfma_f32_16x16x32_bf16 v[68:71], v[100:103], v[24:27], v[68:71]
  v_mfma_f32_16x16x32_bf16 v[68:71], v[104:107], v[12:15], v[68:71]
  v_mfma_f32_16x16x32_bf16 v[68:71], v[104:107], v[28:31], v[68:71]
  v_mfma_f32_16x16x32_bf16 v[68:71], v[108:111], v[16:19], v[68:71]
  v_mfma_f32_16x16x32_bf16 v[68:71], v[108:111], v[32:35], v[68:71]
  v_mfma_f32_16x16x32_bf16 v[68:71], v[112:115], v[20:23], v[68:71]
  v_mfma_f32_16x16x32_bf16 v[68:71], v[112:115], v[36:39], v[68:71]
  ds_read_b64 v[40:41], v7 offset:8704
  ds_read_b64 v[42:43], v7 offset:8736
  ds_read_b64 v[44:45], v7 offset:8768
  ds_read_b64 v[46:47], v7 offset:8800
  ds_read_b64 v[48:49], v7 offset:8832
  ds_read_b64 v[50:51], v7 offset:8864
  ds_read_b64 v[52:53], v7 offset:8896
  ds_read_b64 v[54:55], v7 offset:8928
  s_waitcnt lgkmcnt(0)
  v_mfma_f32_16x16x32_bf16 v[72:75], v[40:43], v[8:11], 0
  v_mfma_f32_16x16x32_bf16 v[72:75], v[40:43], v[24:27], v[72:75]
  v_mfma_f32_16x16x32_bf16 v[72:75], v[44:47], v[12:15], v[72:75]
  v_mfma_f32_16x16x32_bf16 v[72:75], v[44:47], v[28:31], v[72:75]
  v_mfma_f32_16x16x32_bf16 v[72:75], v[48:51], v[16:19], v[72:75]
  v_mfma_f32_16x16x32_bf16 v[72:75], v[48:51], v[32:35], v[72:75]
  v_mfma_f32_16x16x32_bf16 v[72:75], v[52:55], v[20:23], v[72:75]
  v_mfma_f32_16x16x32_bf16 v[72:75], v[52:55], v[36:39], v[72:75]
  ds_read_b64 v[100:101], v7 offset:13056
  ds_read_b64 v[102:103], v7 offset:13088
  ds_read_b64 v[104:105], v7 offset:13120
  ds_read_b64 v[106:107], v7 offset:13152
  ds_read_b64 v[108:109], v7 offset:13184
  ds_read_b64 v[110:111], v7 offset:13216
  ds_read_b64 v[112:113], v7 offset:13248
  ds_read_b64 v[114:115], v7 offset:13280
  s_waitcnt lgkmcnt(0)
  v_mfma_f32_16x16x32_bf16 v[76:79], v[100:103], v[8:11], 0
  v_mfma_f32_16x16x32_bf16 v[76:79], v[100:103], v[24:27], v[76:79]
  v_mfma_f32_16x16x32_bf16 v[76:79], v[104:107], v[12:15], v[76:79]
  v_mfma_f32_16x16x32_bf16 v[76:79], v[104:107], v[28:31], v[76:79]
  v_mfma_f32_16x16x32_bf16 v[76:79], v[108:111], v[16:19], v[76:79]
  v_mfma_f32_16x16x32_bf16 v[76:79], v[108:111], v[32:35], v[76:79]
  v_mfma_f32_16x16x32_bf16 v[76:79], v[112:115], v[20:23], v[76:79]
  v_mfma_f32_16x16x32_bf16 v[76:79], v[112:115], v[36:39], v[76:79]
  ds_read_b64 v[40:41], v7 offset:17408
  ds_read_b64 v[42:43], v7 offset:17440
  ds_read_b64 v[44:45], v7 offset:17472
  ds_read_b64 v[46:47], v7 offset:17504
  ds_read_b64 v[48:49], v7 offset:17536
  ds_read_b64 v[50:51], v7 offset:17568
  ds_read_b64 v[52:53], v7 offset:17600
  ds_read_b64 v[54:55], v7 offset:17632
  s_waitcnt lgkmcnt(0)
  v_mfma_f32_16x16x32_bf16 v[80:83], v[40:43], v[8:11], 0
  v_mfma_f32_16x16x32_bf16 v[80:83], v[40:43], v[24:27], v[80:83]
  v_mfma_f32_16x16x32_bf16 v[80:83], v[44:47], v[12:15], v[80:83]
  v_mfma_f32_16x16x32_bf16 v[80:83], v[44:47], v[28:31], v[80:83]
  v_mfma_f32_16x16x32_bf16 v[80:83], v[48:51], v[16:19], v[80:83]
  v_mfma_f32_16x16x32_bf16 v[80:83], v[48:51], v[32:35], v[80:83]
  v_mfma_f32_16x16x32_bf16 v[80:83], v[52:55], v[20:23], v[80:83]
  v_mfma_f32_16x16x32_bf16 v[80:83], v[52:55], v[36:39], v[80:83]
  ds_read_b64 v[100:101], v7 offset:21760
  ds_read_b64 v[102:103], v7 offset:21792
  ds_read_b64 v[104:105], v7 offset:21824
  ds_read_b64 v[106:107], v7 offset:21856
  ds_read_b64 v[108:109], v7 offset:21888
  ds_read_b64 v[110:111], v7 offset:21920
  ds_read_b64 v[112:113], v7 offset:21952
  ds_read_b64 v[114:115], v7 offset:21984
  s_waitcnt lgkmcnt(0)
  v_mfma_f32_16x16x32_bf16 v[84:87], v[100:103], v[8:11], 0
  v_mfma_f32_16x16x32_bf16 v[84:87], v[100:103], v[24:27], v[84:87]
  v_mfma_f32_16x16x32_bf16 v[84:87], v[104:107], v[12:15], v[84:87]
  v_mfma_f32_16x16x32_bf16 v[84:87], v[104:107], v[28:31], v[84:87]
  v_mfma_f32_16x16x32_bf16 v[84:87], v[108:111], v[16:19], v[84:87]
  v_mfma_f32_16x16x32_bf16 v[84:87], v[108:111], v[32:35], v[84:87]
  v_mfma_f32_16x16x32_bf16 v[84:87], v[112:115], v[20:23], v[84:87]
  v_mfma_f32_16x16x32_bf16 v[84:87], v[112:115], v[36:39], v[84:87]
  ds_read_b64 v[40:41], v7 offset:26112
  ds_read_b64 v[42:43], v7 offset:26144
  ds_read_b64 v[44:45], v7 offset:26176
  ds_read_b64 v[46:47], v7 offset:26208
  ds_read_b64 v[48:49], v7 offset:26240
  ds_read_b64 v[50:51], v7 offset:26272
  ds_read_b64 v[52:53], v7 offset:26304
  ds_read_b64 v[54:55], v7 offset:26336
  s_waitcnt lgkmcnt(0)
  v_mfma_f32_16x16x32_bf16 v[88:91], v[40:43], v[8:11], 0
  v_mfma_f32_16x16x32_bf16 v[88:91], v[40:43], v[24:27], v[88:91]
  v_mfma_f32_16x16x32_bf16 v[88:91], v[44:47], v[12:15], v[88:91]
  v_mfma_f32_16x16x32_bf16 v[88:91], v[44:47], v[28:31], v[88:91]
  v_mfma_f32_16x16x32_bf16 v[88:91], v[48:51], v[16:19], v[88:91]
  v_mfma_f32_16x16x32_bf16 v[88:91], v[48:51], v[32:35], v[88:91]
  v_mfma_f32_16x16x32_bf16 v[88:91], v[52:55], v[20:23], v[88:91]
  v_mfma_f32_16x16x32_bf16 v[88:91], v[52:55], v[36:39], v[88:91]
  ds_read_b64 v[100:101], v7 offset:30464
  ds_read_b64 v[102:103], v7 offset:30496
  ds_read_b64 v[104:105], v7 offset:30528
  ds_read_b64 v[106:107], v7 offset:30560
  ds_read_b64 v[108:109], v7 offset:30592
  ds_read_b64 v[110:111], v7 offset:30624
  ds_read_b64 v[112:113], v7 offset:30656
  ds_read_b64 v[114:115], v7 offset:30688
  s_waitcnt lgkmcnt(0)
  v_mfma_f32_16x16x32_bf16 v[92:95], v[100:103], v[8:11], 0
  v_mfma_f32_16x16x32_bf16 v[92:95], v[100:103], v[24:27], v[92:95]
  v_mfma_f32_16x16x32_bf16 v[92:95], v[104:107], v[12:15], v[92:95]
  v_mfma_f32_16x16x32_bf16 v[92:95], v[104:107], v[28:31], v[92:95]
  v_mfma_f32_16x16x32_bf16 v[92:95], v[108:111], v[16:19], v[92:95]
  v_mfma_f32_16x16x32_bf16 v[92:95], v[108:111], v[32:35], v[92:95]
  v_mfma_f32_16x16x32_bf16 v[92:95], v[112:115], v[20:23], v[92:95]
  v_mfma_f32_16x16x32_bf16 v[92:95], v[112:115], v[36:39], v[92:95]
  v_mov_b32 v9, 1.0
  s_mov_b64 exec, s[30:31]
  s_branch k1_wfin
k2_end:
  s_endpgm
.globl h_kernel
.p2align 8
.type h_kernel,@function
h_kernel:
  s_cmp_ge_u32 s2, 256
  s_cbranch_scc1 h_end
  s_load_dwordx2 s[4:5], s[0:1], 88
  s_load_dwordx2 s[6:7], s[0:1], 24
  v_lshrrev_b32 v2, 6, v0
  v_and_b32 v1, 63, v0
  v_readfirstlane_b32 s12, v2
  s_and_b32 s8, s2, 7
  s_lshl_b32 s8, s8, 2
  s_bfe_u32 s3, s2, 0x20003
  s_add_u32 s8, s8, s3
  s_lshr_b32 s9, s2, 5
  s_mul_i32 s10, s9, 49
  s_add_u32 s11, s10, 49
  s_lshr_b32 s10, s10, 1
  s_lshr_b32 s11, s11, 1
  s_add_u32 s13, s10, s12
  s_add_u32 s14, s13, 16
  s_cmp_lt_u32 s14, s11
  s_cselect_b32 s15, 1, 0
  s_cselect_b32 s27, -1, 0
  s_cselect_b32 s14, s14, s13
  s_mov_b32 s26, -1
  s_mul_i32 s25, s8, 100352
  s_lshr_b32 s3, s12, 1
  s_and_b32 s36, s12, 1
  s_add_u32 s37, s3, s36
  s_mul_i32 s37, s37, 49
  s_lshr_b32 s37, s37, 1
  s_lshl_b32 s37, s37, 9
  s_mul_i32 s36, s36, 6144
  s_sub_u32 s37, s37, s36
  v_lshl_add_u32 v3, v1, 4, s37
  s_add_u32 s37, s25, 25693184
  v_add_u32 v2, s37, v3
  s_lshl_b32 s36, s13, 4
  s_lshl_b32 s37, s14, 4
  s_add_u32 s36, s36, 54842368
  s_add_u32 s37, s37, 54842368
  s_mov_b32 s24, 0
  s_and_b32 s39, s12, 3
  v_lshl_add_u32 v20, s13, 6, v1
  v_lshl_add_u32 v21, s14, 6, v1
  v_min_u32 v22, 12499, v20
  v_min_u32 v23, 12499, v21
  v_lshlrev_b32 v22, 1, v22
  v_lshlrev_b32 v23, 1, v23
  s_lshl_b32 s40, s13, 13
  s_lshl_b32 s41, s14, 13
  s_add_u32 s40, s40, 53240832
  s_add_u32 s41, s41, 53240832
  v_lshl_add_u32 v24, v1, 4, s40
  v_lshl_add_u32 v25, v1, 4, s41
  s_waitcnt lgkmcnt(0)
  s_load_dwordx4 s[16:19], s[4:5], s36
  s_load_dwordx4 s[20:23], s[4:5], s37
  s_add_u32 s28, s4, 3211264
  s_addc_u32 s29, s5, 0
  global_load_dwordx4 v[32:35], v2, s[4:5] offset:-3072
  global_load_dwordx4 v[36:39], v2, s[4:5] offset:-2048
  global_load_dwordx4 v[40:43], v2, s[4:5] offset:-1024
  global_load_dwordx4 v[44:47], v2, s[4:5] offset:0
  global_load_dwordx4 v[48:51], v2, s[4:5] offset:1024
  global_load_dwordx4 v[52:55], v2, s[4:5] offset:2048
  s_cmp_lg_u32 s39, 2
  s_cbranch_scc1 hf_n7
  s_mov_b32 exec_hi, 0
  global_load_dwordx4 v[56:59], v2, s[4:5] offset:3072
  s_mov_b32 exec_hi, -1
hf_n7:
  global_load_ushort v16, v22, s[6:7]
  global_load_ushort v17, v23, s[6:7]
  s_cmp_ge_u32 s12, 16
  s_cbranch_scc0 hf_pa
  s_waitcnt vmcnt(0)
  s_branch hf_pb
hf_pa:
  global_load_dwordx4 v[84:87], v24, s[4:5] offset:1024
  global_load_dwordx4 v[80:83], v24, s[4:5] offset:0
  global_load_dwordx4 v[76:79], v24, s[4:5] offset:-1024
  global_load_dwordx4 v[72:75], v24, s[4:5] offset:-2048
  global_load_dwordx4 v[68:71], v24, s[4:5] offset:-3072
  global_load_dwordx4 v[64:67], v24, s[4:5] offset:-4096
  s_waitcnt vmcnt(6)
hf_pb:
  ds_write_b128 v3, v[32:35] offset:0
  ds_write_b128 v3, v[36:39] offset:1024
  ds_write_b128 v3, v[40:43] offset:2048
  ds_write_b128 v3, v[44:47] offset:3072
  ds_write_b128 v3, v[48:51] offset:4096
  ds_write_b128 v3, v[52:55] offset:5120
  s_cmp_lg_u32 s39, 2
  s_cbranch_scc1 h_w7
  s_mov_b32 exec_hi, 0
  ds_write_b128 v3, v[56:59] offset:6144
  s_mov_b32 exec_hi, -1
h_w7:
  s_waitcnt lgkmcnt(0)
  s_cmp_ge_u32 s12, 16
  s_cbranch_scc1 hf_ca
  s_cmp_le_u32 s16, 48
  s_cbranch_scc1 hf_ca
  global_load_dwordx4 v[88:91], v24, s[4:5] offset:2048
  s_cmp_le_u32 s16, 56
  s_cbranch_scc1 hf_ca
  global_load_dwordx4 v[92:95], v24, s[4:5] offset:3072
hf_ca:
  v_bfe_u32 v26, v1, 4, 1
  v_bfe_u32 v27, v1, 3, 1
  v_cmp_eq_u32 vcc, v26, v27
  v_mov_b32 v29, 0x3f80
  s_nop 0
  v_cndmask_b32 v29, 0, v29, vcc
  v_and_b32 v28, 4, v1
  v_cmp_eq_u32 vcc, 0, v28
  s_nop 1
  v_cndmask_b32 v8, 0, v29, vcc
  v_cndmask_b32 v9, 0, v29, vcc
  v_cndmask_b32 v10, v29, 0, vcc
  v_cndmask_b32 v11, v29, 0, vcc
  v_and_b32 v26, 3, v1
  v_add_u32 v27, 1, v26
  v_and_b32 v27, 3, v27
  v_lshl_or_b32 v26, v27, 2, v26
  v_mul_u32_u24 v7, 0x1111, v26
  s_mov_b32 s32, 0x55555555
  s_mov_b32 s33, 0x55555555
  s_not_b64 s[34:35], s[32:33]
  v_mov_b32 v26, 0
  v_mov_b32 v27, 25690112
  v_cndmask_b32 v26, v26, v27, s[32:33]
  v_add_u32 v26, s25, v26
  v_and_b32 v27, -2, v20
  v_lshl_add_u32 v18, v27, 3, v26
  v_and_b32 v27, -2, v21
  v_lshl_add_u32 v19, v27, 3, v26
  v_lshlrev_b32 v16, 16, v16
  v_lshlrev_b32 v17, 16, v17
  v_cmp_gt_u32 vcc, 12500, v20
  s_nop 1
  v_cndmask_b32 v16, 0, v16, vcc
  v_cmp_gt_u32 vcc, 12500, v21
  s_nop 1
  v_cndmask_b32 v17, 0, v17, vcc
  v_lshlrev_b32 v0, 3, v20
  v_and_b32 v26, 31, v1
  v_lshrrev_b32 v27, 5, v1
  v_lshlrev_b32 v27, 13, v27
  v_lshl_add_u32 v26, v26, 4, v27
  s_lshl_b32 s36, s13, 9
  s_add_u32 s36, s36, s25
  s_add_u32 s36, s36, 25690112
  v_add_u32 v5, s36, v26
  s_mov_b32 s30, 16384
  s_add_u32 s3, s9, s12
  s_and_b32 s3, s3, 7
  s_and_b32 s31, s3, 1
  s_sub_u32 s31, 0, s31
  s_mul_i32 s36, s3, 49
  s_lshr_b32 s36, s36, 1
  s_lshl_b32 s36, s36, 9
  s_add_u32 s37, s25, 25694208
  s_cmp_lt_u32 s12, 9
  s_cbranch_scc1 h_np
  v_lshl_add_u32 v3, v1, 4, s36
  v_add_u32 v2, s37, v3
  v_add_u32 v19, 8192, v2
  v_and_b32 v17, 7, v1
  s_lshl_b32 s36, s8, 10
  s_add_u32 s36, s36, 56520960
  v_lshl_add_u32 v17, v17, 7, s36
h_np:
  s_mov_b64 s[6:7], s[28:29]
  s_mov_b64 s[10:11], s[4:5]
  s_mov_b64 exec, s[26:27]
  global_load_dword v31, v5, s[6:7]
  s_mov_b64 exec, -1
  s_mov_b32 s8, 1
  s_mov_b32 s13, 1
  s_mov_b32 s14, 1
  s_xor_b32 s36, s15, 1
  s_or_b32 s23, s23, s36
  v_mov_b32 v12, 0
  v_mov_b32 v13, 0
  v_mov_b32 v14, 0
  v_mov_b32 v15, 0
  s_mov_b32 s27, 0x10000
  s_mov_b32 s26, 0
  s_setprio 3
  s_cmp_ge_u32 s12, 8
  s_cbranch_scc1 hf_pr
  s_setprio 2
hf_pr:
  s_barrier
  s_cmp_eq_u32 s15, 0
  s_cbranch_scc1 hf_nb
  v_mov_b32 v2, 0
  v_mov_b32 v3, 0
  v_mov_b32 v4, 0
  v_mov_b32 v5, 0
  s_cmp_le_u32 s20, 48
  s_cbranch_scc1 hf_cb
  global_load_dwordx4 v[120:123], v25, s[4:5] offset:2048
  s_cmp_le_u32 s20, 56
  s_cbranch_scc1 hf_cb
  global_load_dwordx4 v[124:127], v25, s[4:5] offset:3072
hf_cb:
  global_load_dwordx4 v[116:119], v25, s[4:5] offset:1024
  global_load_dwordx4 v[112:115], v25, s[4:5] offset:0
  global_load_dwordx4 v[108:111], v25, s[4:5] offset:-1024
  global_load_dwordx4 v[104:107], v25, s[4:5] offset:-2048
  global_load_dwordx4 v[100:103], v25, s[4:5] offset:-3072
  global_load_dwordx4 v[96:99], v25, s[4:5] offset:-4096
  s_waitcnt vmcnt(6)
  s_branch h_tokd
hf_nb:
  s_cmp_ge_u32 s12, 16
  s_cbranch_scc0 hf_pc
  s_cmp_le_u32 s16, 48
  s_cbranch_scc1 hf_cc
  global_load_dwordx4 v[88:91], v24, s[4:5] offset:2048
  s_cmp_le_u32 s16, 56
  s_cbranch_scc1 hf_cc
  global_load_dwordx4 v[92:95], v24, s[4:5] offset:3072
hf_cc:
  global_load_dwordx4 v[84:87], v24, s[4:5] offset:1024
  global_load_dwordx4 v[80:83], v24, s[4:5] offset:0
  global_load_dwordx4 v[76:79], v24, s[4:5] offset:-1024
  global_load_dwordx4 v[72:75], v24, s[4:5] offset:-2048
  global_load_dwordx4 v[68:71], v24, s[4:5] offset:-3072
  global_load_dwordx4 v[64:67], v24, s[4:5] offset:-4096
hf_pc:
  s_waitcnt vmcnt(0)
  s_branch h_tokd
h_top:
  s_add_u32 s8, s24, 2
  s_bfe_u32 s8, s8, 0x10001
  s_lshl_b32 s27, s8, 16
  s_xor_b32 s26, s27, 0x10000
  s_setprio 2
  s_cmp_ge_u32 s12, 8
  s_cbranch_scc1 h_pr
  s_setprio 3
h_pr:
  v_mov_b32 v12, 0
  v_mov_b32 v13, 0
  v_mov_b32 v14, 0
  v_mov_b32 v15, 0
  s_waitcnt lgkmcnt(0)
  s_cmp_ge_u32 s12, 9
  s_cbranch_scc1 h_bl
  v_mov_b32 v2, 0
  v_mov_b32 v3, 0
  v_mov_b32 v4, 0
  v_mov_b32 v5, 0
  s_mov_b32 s13, s19
  s_mov_b32 s14, s23
  s_barrier
  s_setprio 0
  s_or_b32 s36, s13, s14
  s_cbranch_scc1 h_es
  v_mad_u32_u16 v32, v64, 8, 0 op_sel:[0,0,0,0]
  v_mad_u32_u16 v34, v64, 8, 0 op_sel:[1,0,0,0]
  v_mad_u32_u16 v36, v65, 8, 0 op_sel:[0,0,0,0]
  v_mad_u32_u16 v38, v65, 8, 0 op_sel:[1,0,0,0]
  ds_read_b64 v[32:33], v32
  ds_read_b64 v[34:35], v34
  ds_read_b64 v[36:37], v36
  ds_read_b64 v[38:39], v38
  v_mad_u32_u16 v40, v96, 8, 0 op_sel:[0,0,0,0]
  v_mad_u32_u16 v42, v96, 8, 0 op_sel:[1,0,0,0]
  v_mad_u32_u16 v44, v97, 8, 0 op_sel:[0,0,0,0]
  v_mad_u32_u16 v46, v97, 8, 0 op_sel:[1,0,0,0]
  ds_read_b64 v[40:41], v40
  ds_read_b64 v[42:43], v42
  ds_read_b64 v[44:45], v44
  ds_read_b64 v[46:47], v46
  v_mad_u32_u16 v48, v66, 8, 0 op_sel:[0,0,0,0]
  v_mad_u32_u16 v50, v66, 8, 0 op_sel:[1,0,0,0]
  v_mad_u32_u16 v52, v67, 8, 0 op_sel:[0,0,0,0]
  v_mad_u32_u16 v54, v67, 8, 0 op_sel:[1,0,0,0]
  ds_read_b64 v[48:49], v48
  ds_read_b64 v[50:51], v50
  ds_read_b64 v[52:53], v52
  ds_read_b64 v[54:55], v54
  v_mad_u32_u16 v56, v98, 8, 0 op_sel:[0,0,0,0]
  v_mad_u32_u16 v58, v98, 8, 0 op_sel:[1,0,0,0]
  v_mad_u32_u16 v60, v99, 8, 0 op_sel:[0,0,0,0]
  v_mad_u32_u16 v62, v99, 8, 0 op_sel:[1,0,0,0]
  ds_read_b64 v[56:57], v56
  ds_read_b64 v[58:59], v58
  ds_read_b64 v[60:61], v60
  ds_read_b64 v[62:63], v62
  s_waitcnt lgkmcnt(12)
  v_smfmac_f32_16x16x64_bf16 v[12:15], v[8:11], v[32:39], v7
  s_waitcnt lgkmcnt(8)
  v_smfmac_f32_16x16x64_bf16 v[2:5], v[8:11], v[40:47], v7
  s_waitcnt lgkmcnt(4)
  v_smfmac_f32_16x16x64_bf16 v[12:15], v[8:11], v[48:55], v7
  s_waitcnt lgkmcnt(0)
  v_smfmac_f32_16x16x64_bf16 v[2:5], v[8:11], v[56:63], v7
  s_branch h_eb
h_es:
  s_cmp_lg_u32 s13, 0
  s_cbranch_scc1 h_ea
  v_mad_u32_u16 v40, v66, 8, 0 op_sel:[0,0,0,0]
  v_mad_u32_u16 v42, v66, 8, 0 op_sel:[1,0,0,0]
  v_mad_u32_u16 v44, v67, 8, 0 op_sel:[0,0,0,0]
  v_mad_u32_u16 v46, v67, 8, 0 op_sel:[1,0,0,0]
  ds_read_b64 v[40:41], v40
  ds_read_b64 v[42:43], v42
  ds_read_b64 v[44:45], v44
  ds_read_b64 v[46:47], v46
  v_mad_u32_u16 v32, v64, 8, 0 op_sel:[0,0,0,0]
  v_mad_u32_u16 v34, v64, 8, 0 op_sel:[1,0,0,0]
  v_mad_u32_u16 v36, v65, 8, 0 op_sel:[0,0,0,0]
  v_mad_u32_u16 v38, v65, 8, 0 op_sel:[1,0,0,0]
  ds_read_b64 v[32:33], v32
  ds_read_b64 v[34:35], v34
  ds_read_b64 v[36:37], v36
  ds_read_b64 v[38:39], v38
  s_waitcnt lgkmcnt(4)
  v_smfmac_f32_16x16x64_bf16 v[12:15], v[8:11], v[40:47], v7
  s_waitcnt lgkmcnt(0)
  v_smfmac_f32_16x16x64_bf16 v[12:15], v[8:11], v[32:39], v7
h_ea:
  s_cmp_lg_u32 s14, 0
  s_cbranch_scc1 h_eb
  v_mad_u32_u16 v40, v98, 8, 0 op_sel:[0,0,0,0]
  v_mad_u32_u16 v42, v98, 8, 0 op_sel:[1,0,0,0]
  v_mad_u32_u16 v44, v99, 8, 0 op_sel:[0,0,0,0]
  v_mad_u32_u16 v46, v99, 8, 0 op_sel:[1,0,0,0]
  ds_read_b64 v[40:41], v40
  ds_read_b64 v[42:43], v42
  ds_read_b64 v[44:45], v44
  ds_read_b64 v[46:47], v46
  v_mad_u32_u16 v32, v96, 8, 0 op_sel:[0,0,0,0]
  v_mad_u32_u16 v34, v96, 8, 0 op_sel:[1,0,0,0]
  v_mad_u32_u16 v36, v97, 8, 0 op_sel:[0,0,0,0]
  v_mad_u32_u16 v38, v97, 8, 0 op_sel:[1,0,0,0]
  ds_read_b64 v[32:33], v32
  ds_read_b64 v[34:35], v34
  ds_read_b64 v[36:37], v36
  ds_read_b64 v[38:39], v38
  s_waitcnt lgkmcnt(4)
  v_smfmac_f32_16x16x64_bf16 v[2:5], v[8:11], v[40:47], v7
  s_waitcnt lgkmcnt(0)
  v_smfmac_f32_16x16x64_bf16 v[2:5], v[8:11], v[32:39], v7
h_eb:
  s_setprio 3
h_bl:
  s_barrier
  s_cmp_eq_u32 s24, 6
  s_cbranch_scc1 h_tok
h_tokd:
  s_cmp_eq_u32 s16, 48
  s_cbranch_scc1 ga_e12
  s_cmp_eq_u32 s16, 44
  s_cbranch_scc1 ga_e11
  s_cmp_eq_u32 s16, 52
  s_cbranch_scc1 ga_e13
  s_cmp_eq_u32 s16, 40
  s_cbranch_scc1 ga_e10
  s_cmp_eq_u32 s16, 56
  s_cbranch_scc1 ga_e14
  s_cmp_eq_u32 s16, 36
  s_cbranch_scc1 ga_e9
  s_cmp_eq_u32 s16, 60
  s_cbranch_scc1 ga_e15
  s_cmp_eq_u32 s16, 32
  s_cbranch_scc1 ga_e8
  v_mad_u32_u16 v56, v94, 8, 0 op_sel:[0,0,0,0]
  v_mad_u32_u16 v58, v94, 8, 0 op_sel:[1,0,0,0]
  v_mad_u32_u16 v60, v95, 8, 0 op_sel:[0,0,0,0]
  v_mad_u32_u16 v62, v95, 8, 0 op_sel:[1,0,0,0]
  ds_read_b64 v[56:57], v56
  ds_read_b64 v[58:59], v58
  ds_read_b64 v[60:61], v60
  ds_read_b64 v[62:63], v62
  v_mad_u32_u16 v48, v92, 8, 0 op_sel:[0,0,0,0]
  v_mad_u32_u16 v50, v92, 8, 0 op_sel:[1,0,0,0]
  v_mad_u32_u16 v52, v93, 8, 0 op_sel:[0,0,0,0]
  v_mad_u32_u16 v54, v93, 8, 0 op_sel:[1,0,0,0]
  ds_read_b64 v[48:49], v48
  ds_read_b64 v[50:51], v50
  ds_read_b64 v[52:53], v52
  ds_read_b64 v[54:55], v54
  v_mad_u32_u16 v40, v90, 8, 0 op_sel:[0,0,0,0]
  v_mad_u32_u16 v42, v90, 8, 0 op_sel:[1,0,0,0]
  v_mad_u32_u16 v44, v91, 8, 0 op_sel:[0,0,0,0]
  v_mad_u32_u16 v46, v91, 8, 0 op_sel:[1,0,0,0]
  ds_read_b64 v[40:41], v40
  ds_read_b64 v[42:43], v42
  ds_read_b64 v[44:45], v44
  ds_read_b64 v[46:47], v46
  s_branch ga_p12
ga_e12:
  v_mad_u32_u16 v56, v86, 8, 0 op_sel:[0,0,0,0]
  v_mad_u32_u16 v58, v86, 8, 0 op_sel:[1,0,0,0]
  v_mad_u32_u16 v60, v87, 8, 0 op_sel:[0,0,0,0]
  v_mad_u32_u16 v62, v87, 8, 0 op_sel:[1,0,0,0]
  ds_read_b64 v[56:57], v56
  ds_read_b64 v[58:59], v58
  ds_read_b64 v[60:61], v60
  ds_read_b64 v[62:63], v62
  v_mad_u32_u16 v48, v84, 8, 0 op_sel:[0,0,0,0]
  v_mad_u32_u16 v50, v84, 8, 0 op_sel:[1,0,0,0]
  v_mad_u32_u16 v52, v85, 8, 0 op_sel:[0,0,0,0]
  v_mad_u32_u16 v54, v85, 8, 0 op_sel:[1,0,0,0]
  ds_read_b64 v[48:49], v48
  ds_read_b64 v[50:51], v50
  ds_read_b64 v[52:53], v52
  ds_read_b64 v[54:55], v54
  v_mad_u32_u16 v40, v82, 8, 0 op_sel:[0,0,0,0]
  v_mad_u32_u16 v42, v82, 8, 0 op_sel:[1,0,0,0]
  v_mad_u32_u16 v44, v83, 8, 0 op_sel:[0,0,0,0]
  v_mad_u32_u16 v46, v83, 8, 0 op_sel:[1,0,0,0]
  ds_read_b64 v[40:41], v40
  ds_read_b64 v[42:43], v42
  ds_read_b64 v[44:45], v44
  ds_read_b64 v[46:47], v46
  s_branch ga_p8
ga_e11:
  v_mad_u32_u16 v48, v84, 8, 0 op_sel:[0,0,0,0]
  v_mad_u32_u16 v50, v84, 8, 0 op_sel:[1,0,0,0]
  v_mad_u32_u16 v52, v85, 8, 0 op_sel:[0,0,0,0]
  v_mad_u32_u16 v54, v85, 8, 0 op_sel:[1,0,0,0]
  ds_read_b64 v[48:49], v48
  ds_read_b64 v[50:51], v50
  ds_read_b64 v[52:53], v52
  ds_read_b64 v[54:55], v54
  v_mad_u32_u16 v40, v82, 8, 0 op_sel:[0,0,0,0]
  v_mad_u32_u16 v42, v82, 8, 0 op_sel:[1,0,0,0]
  v_mad_u32_u16 v44, v83, 8, 0 op_sel:[0,0,0,0]
  v_mad_u32_u16 v46, v83, 8, 0 op_sel:[1,0,0,0]
  ds_read_b64 v[40:41], v40
  ds_read_b64 v[42:43], v42
  ds_read_b64 v[44:45], v44
  ds_read_b64 v[46:47], v46
  v_mad_u32_u16 v32, v80, 8, 0 op_sel:[0,0,0,0]
  v_mad_u32_u16 v34, v80, 8, 0 op_sel:[1,0,0,0]
  v_mad_u32_u16 v36, v81, 8, 0 op_sel:[0,0,0,0]
  v_mad_u32_u16 v38, v81, 8, 0 op_sel:[1,0,0,0]
  ds_read_b64 v[32:33], v32
  ds_read_b64 v[34:35], v34
  ds_read_b64 v[36:37], v36
  ds_read_b64 v[38:39], v38
  s_branch ga_p7
ga_e13:
  v_mad_u32_u16 v32, v88, 8, 0 op_sel:[0,0,0,0]
  v_mad_u32_u16 v34, v88, 8, 0 op_sel:[1,0,0,0]
  v_mad_u32_u16 v36, v89, 8, 0 op_sel:[0,0,0,0]
  v_mad_u32_u16 v38, v89, 8, 0 op_sel:[1,0,0,0]
  ds_read_b64 v[32:33], v32
  ds_read_b64 v[34:35], v34
  ds_read_b64 v[36:37], v36
  ds_read_b64 v[38:39], v38
  v_mad_u32_u16 v56, v86, 8, 0 op_sel:[0,0,0,0]
  v_mad_u32_u16 v58, v86, 8, 0 op_sel:[1,0,0,0]
  v_mad_u32_u16 v60, v87, 8, 0 op_sel:[0,0,0,0]
  v_mad_u32_u16 v62, v87, 8, 0 op_sel:[1,0,0,0]
  ds_read_b64 v[56:57], v56
  ds_read_b64 v[58:59], v58
  ds_read_b64 v[60:61], v60
  ds_read_b64 v[62:63], v62
  v_mad_u32_u16 v48, v84, 8, 0 op_sel:[0,0,0,0]
  v_mad_u32_u16 v50, v84, 8, 0 op_sel:[1,0,0,0]
  v_mad_u32_u16 v52, v85, 8, 0 op_sel:[0,0,0,0]
  v_mad_u32_u16 v54, v85, 8, 0 op_sel:[1,0,0,0]
  ds_read_b64 v[48:49], v48
  ds_read_b64 v[50:51], v50
  ds_read_b64 v[52:53], v52
  ds_read_b64 v[54:55], v54
  s_branch ga_p9
ga_e10:
  v_mad_u32_u16 v40, v82, 8, 0 op_sel:[0,0,0,0]
  v_mad_u32_u16 v42, v82, 8, 0 op_sel:[1,0,0,0]
  v_mad_u32_u16 v44, v83, 8, 0 op_sel:[0,0,0,0]
  v_mad_u32_u16 v46, v83, 8, 0 op_sel:[1,0,0,0]
  ds_read_b64 v[40:41], v40
  ds_read_b64 v[42:43], v42
  ds_read_b64 v[44:45], v44
  ds_read_b64 v[46:47], v46
  v_mad_u32_u16 v32, v80, 8, 0 op_sel:[0,0,0,0]
  v_mad_u32_u16 v34, v80, 8, 0 op_sel:[1,0,0,0]
  v_mad_u32_u16 v36, v81, 8, 0 op_sel:[0,0,0,0]
  v_mad_u32_u16 v38, v81, 8, 0 op_sel:[1,0,0,0]
  ds_read_b64 v[32:33], v32
  ds_read_b64 v[34:35], v34
  ds_read_b64 v[36:37], v36
  ds_read_b64 v[38:39], v38
  v_mad_u32_u16 v56, v78, 8, 0 op_sel:[0,0,0,0]
  v_mad_u32_u16 v58, v78, 8, 0 op_sel:[1,0,0,0]
  v_mad_u32_u16 v60, v79, 8, 0 op_sel:[0,0,0,0]
  v_mad_u32_u16 v62, v79, 8, 0 op_sel:[1,0,0,0]
  ds_read_b64 v[56:57], v56
  ds_read_b64 v[58:59], v58
  ds_read_b64 v[60:61], v60
  ds_read_b64 v[62:63], v62
  s_branch ga_p6
ga_e14:
  v_mad_u32_u16 v40, v90, 8, 0 op_sel:[0,0,0,0]
  v_mad_u32_u16 v42, v90, 8, 0 op_sel:[1,0,0,0]
  v_mad_u32_u16 v44, v91, 8, 0 op_sel:[0,0,0,0]
  v_mad_u32_u16 v46, v91, 8, 0 op_sel:[1,0,0,0]
  ds_read_b64 v[40:41], v40
  ds_read_b64 v[42:43], v42
  ds_read_b64 v[44:45], v44
  ds_read_b64 v[46:47], v46
  v_mad_u32_u16 v32, v88, 8, 0 op_sel:[0,0,0,0]
  v_mad_u32_u16 v34, v88, 8, 0 op_sel:[1,0,0,0]
  v_mad_u32_u16 v36, v89, 8, 0 op_sel:[0,0,0,0]
  v_mad_u32_u16 v38, v89, 8, 0 op_sel:[1,0,0,0]
  ds_read_b64 v[32:33], v32
  ds_read_b64 v[34:35], v34
  ds_read_b64 v[36:37], v36
  ds_read_b64 v[38:39], v38
  v_mad_u32_u16 v56, v86, 8, 0 op_sel:[0,0,0,0]
  v_mad_u32_u16 v58, v86, 8, 0 op_sel:[1,0,0,0]
  v_mad_u32_u16 v60, v87, 8, 0 op_sel:[0,0,0,0]
  v_mad_u32_u16 v62, v87, 8, 0 op_sel:[1,0,0,0]
  ds_read_b64 v[56:57], v56
  ds_read_b64 v[58:59], v58
  ds_read_b64 v[60:61], v60
  ds_read_b64 v[62:63], v62
  s_branch ga_p10
ga_e9:
  v_mad_u32_u16 v32, v80, 8, 0 op_sel:[0,0,0,0]
  v_mad_u32_u16 v34, v80, 8, 0 op_sel:[1,0,0,0]
  v_mad_u32_u16 v36, v81, 8, 0 op_sel:[0,0,0,0]
  v_mad_u32_u16 v38, v81, 8, 0 op_sel:[1,0,0,0]
  ds_read_b64 v[32:33], v32
  ds_read_b64 v[34:35], v34
  ds_read_b64 v[36:37], v36
  ds_read_b64 v[38:39], v38
  v_mad_u32_u16 v56, v78, 8, 0 op_sel:[0,0,0,0]
  v_mad_u32_u16 v58, v78, 8, 0 op_sel:[1,0,0,0]
  v_mad_u32_u16 v60, v79, 8, 0 op_sel:[0,0,0,0]
  v_mad_u32_u16 v62, v79, 8, 0 op_sel:[1,0,0,0]
  ds_read_b64 v[56:57], v56
  ds_read_b64 v[58:59], v58
  ds_read_b64 v[60:61], v60
  ds_read_b64 v[62:63], v62
  v_mad_u32_u16 v48, v76, 8, 0 op_sel:[0,0,0,0]
  v_mad_u32_u16 v50, v76, 8, 0 op_sel:[1,0,0,0]
  v_mad_u32_u16 v52, v77, 8, 0 op_sel:[0,0,0,0]
  v_mad_u32_u16 v54, v77, 8, 0 op_sel:[1,0,0,0]
  ds_read_b64 v[48:49], v48
  ds_read_b64 v[50:51], v50
  ds_read_b64 v[52:53], v52
  ds_read_b64 v[54:55], v54
  s_branch ga_p5
ga_e15:
  v_mad_u32_u16 v48, v92, 8, 0 op_sel:[0,0,0,0]
  v_mad_u32_u16 v50, v92, 8, 0 op_sel:[1,0,0,0]
  v_mad_u32_u16 v52, v93, 8, 0 op_sel:[0,0,0,0]
  v_mad_u32_u16 v54, v93, 8, 0 op_sel:[1,0,0,0]
  ds_read_b64 v[48:49], v48
  ds_read_b64 v[50:51], v50
  ds_read_b64 v[52:53], v52
  ds_read_b64 v[54:55], v54
  v_mad_u32_u16 v40, v90, 8, 0 op_sel:[0,0,0,0]
  v_mad_u32_u16 v42, v90, 8, 0 op_sel:[1,0,0,0]
  v_mad_u32_u16 v44, v91, 8, 0 op_sel:[0,0,0,0]
  v_mad_u32_u16 v46, v91, 8, 0 op_sel:[1,0,0,0]
  ds_read_b64 v[40:41], v40
  ds_read_b64 v[42:43], v42
  ds_read_b64 v[44:45], v44
  ds_read_b64 v[46:47], v46
  v_mad_u32_u16 v32, v88, 8, 0 op_sel:[0,0,0,0]
  v_mad_u32_u16 v34, v88, 8, 0 op_sel:[1,0,0,0]
  v_mad_u32_u16 v36, v89, 8, 0 op_sel:[0,0,0,0]
  v_mad_u32_u16 v38, v89, 8, 0 op_sel:[1,0,0,0]
  ds_read_b64 v[32:33], v32
  ds_read_b64 v[34:35], v34
  ds_read_b64 v[36:37], v36
  ds_read_b64 v[38:39], v38
  s_branch ga_p11
ga_e8:
  v_mad_u32_u16 v56, v78, 8, 0 op_sel:[0,0,0,0]
  v_mad_u32_u16 v58, v78, 8, 0 op_sel:[1,0,0,0]
  v_mad_u32_u16 v60, v79, 8, 0 op_sel:[0,0,0,0]
  v_mad_u32_u16 v62, v79, 8, 0 op_sel:[1,0,0,0]
  ds_read_b64 v[56:57], v56
  ds_read_b64 v[58:59], v58
  ds_read_b64 v[60:61], v60
  ds_read_b64 v[62:63], v62
  v_mad_u32_u16 v48, v76, 8, 0 op_sel:[0,0,0,0]
  v_mad_u32_u16 v50, v76, 8, 0 op_sel:[1,0,0,0]
  v_mad_u32_u16 v52, v77, 8, 0 op_sel:[0,0,0,0]
  v_mad_u32_u16 v54, v77, 8, 0 op_sel:[1,0,0,0]
  ds_read_b64 v[48:49], v48
  ds_read_b64 v[50:51], v50
  ds_read_b64 v[52:53], v52
  ds_read_b64 v[54:55], v54
  v_mad_u32_u16 v40, v74, 8, 0 op_sel:[0,0,0,0]
  v_mad_u32_u16 v42, v74, 8, 0 op_sel:[1,0,0,0]
  v_mad_u32_u16 v44, v75, 8, 0 op_sel:[0,0,0,0]
  v_mad_u32_u16 v46, v75, 8, 0 op_sel:[1,0,0,0]
  ds_read_b64 v[40:41], v40
  ds_read_b64 v[42:43], v42
  ds_read_b64 v[44:45], v44
  ds_read_b64 v[46:47], v46
  s_branch ga_p4
ga_dr:
  s_waitcnt lgkmcnt(8)
  v_smfmac_f32_16x16x64_bf16 v[12:15], v[8:11], v[32:39], v7
  s_waitcnt lgkmcnt(4)
  v_smfmac_f32_16x16x64_bf16 v[12:15], v[8:11], v[56:63], v7
  s_waitcnt lgkmcnt(0)
  v_smfmac_f32_16x16x64_bf16 v[12:15], v[8:11], v[48:55], v7
  s_branch ga_dd
ga_p12:
  v_mad_u32_u16 v32, v88, 8, 0 op_sel:[0,0,0,0]
  v_mad_u32_u16 v34, v88, 8, 0 op_sel:[1,0,0,0]
  v_mad_u32_u16 v36, v89, 8, 0 op_sel:[0,0,0,0]
  v_mad_u32_u16 v38, v89, 8, 0 op_sel:[1,0,0,0]
  ds_read_b64 v[32:33], v32
  ds_read_b64 v[34:35], v34
  ds_read_b64 v[36:37], v36
  ds_read_b64 v[38:39], v38
  s_waitcnt lgkmcnt(12)
  v_smfmac_f32_16x16x64_bf16 v[12:15], v[8:11], v[56:63], v7
ga_p11:
  v_mad_u32_u16 v56, v86, 8, 0 op_sel:[0,0,0,0]
  v_mad_u32_u16 v58, v86, 8, 0 op_sel:[1,0,0,0]
  v_mad_u32_u16 v60, v87, 8, 0 op_sel:[0,0,0,0]
  v_mad_u32_u16 v62, v87, 8, 0 op_sel:[1,0,0,0]
  ds_read_b64 v[56:57], v56
  ds_read_b64 v[58:59], v58
  ds_read_b64 v[60:61], v60
  ds_read_b64 v[62:63], v62
  s_waitcnt lgkmcnt(12)
  v_smfmac_f32_16x16x64_bf16 v[12:15], v[8:11], v[48:55], v7
ga_p10:
  v_mad_u32_u16 v48, v84, 8, 0 op_sel:[0,0,0,0]
  v_mad_u32_u16 v50, v84, 8, 0 op_sel:[1,0,0,0]
  v_mad_u32_u16 v52, v85, 8, 0 op_sel:[0,0,0,0]
  v_mad_u32_u16 v54, v85, 8, 0 op_sel:[1,0,0,0]
  ds_read_b64 v[48:49], v48
  ds_read_b64 v[50:51], v50
  ds_read_b64 v[52:53], v52
  ds_read_b64 v[54:55], v54
  s_waitcnt lgkmcnt(12)
  v_smfmac_f32_16x16x64_bf16 v[12:15], v[8:11], v[40:47], v7
ga_p9:
  v_mad_u32_u16 v40, v82, 8, 0 op_sel:[0,0,0,0]
  v_mad_u32_u16 v42, v82, 8, 0 op_sel:[1,0,0,0]
  v_mad_u32_u16 v44, v83, 8, 0 op_sel:[0,0,0,0]
  v_mad_u32_u16 v46, v83, 8, 0 op_sel:[1,0,0,0]
  ds_read_b64 v[40:41], v40
  ds_read_b64 v[42:43], v42
  ds_read_b64 v[44:45], v44
  ds_read_b64 v[46:47], v46
  s_waitcnt lgkmcnt(12)
  v_smfmac_f32_16x16x64_bf16 v[12:15], v[8:11], v[32:39], v7
ga_p8:
  v_mad_u32_u16 v32, v80, 8, 0 op_sel:[0,0,0,0]
  v_mad_u32_u16 v34, v80, 8, 0 op_sel:[1,0,0,0]
  v_mad_u32_u16 v36, v81, 8, 0 op_sel:[0,0,0,0]
  v_mad_u32_u16 v38, v81, 8, 0 op_sel:[1,0,0,0]
  ds_read_b64 v[32:33], v32
  ds_read_b64 v[34:35], v34
  ds_read_b64 v[36:37], v36
  ds_read_b64 v[38:39], v38
  s_waitcnt lgkmcnt(12)
  v_smfmac_f32_16x16x64_bf16 v[12:15], v[8:11], v[56:63], v7
ga_p7:
  v_mad_u32_u16 v56, v78, 8, 0 op_sel:[0,0,0,0]
  v_mad_u32_u16 v58, v78, 8, 0 op_sel:[1,0,0,0]
  v_mad_u32_u16 v60, v79, 8, 0 op_sel:[0,0,0,0]
  v_mad_u32_u16 v62, v79, 8, 0 op_sel:[1,0,0,0]
  ds_read_b64 v[56:57], v56
  ds_read_b64 v[58:59], v58
  ds_read_b64 v[60:61], v60
  ds_read_b64 v[62:63], v62
  s_waitcnt lgkmcnt(12)
  v_smfmac_f32_16x16x64_bf16 v[12:15], v[8:11], v[48:55], v7
ga_p6:
  v_mad_u32_u16 v48, v76, 8, 0 op_sel:[0,0,0,0]
  v_mad_u32_u16 v50, v76, 8, 0 op_sel:[1,0,0,0]
  v_mad_u32_u16 v52, v77, 8, 0 op_sel:[0,0,0,0]
  v_mad_u32_u16 v54, v77, 8, 0 op_sel:[1,0,0,0]
  ds_read_b64 v[48:49], v48
  ds_read_b64 v[50:51], v50
  ds_read_b64 v[52:53], v52
  ds_read_b64 v[54:55], v54
  s_waitcnt lgkmcnt(12)
  v_smfmac_f32_16x16x64_bf16 v[12:15], v[8:11], v[40:47], v7
ga_p5:
  v_mad_u32_u16 v40, v74, 8, 0 op_sel:[0,0,0,0]
  v_mad_u32_u16 v42, v74, 8, 0 op_sel:[1,0,0,0]
  v_mad_u32_u16 v44, v75, 8, 0 op_sel:[0,0,0,0]
  v_mad_u32_u16 v46, v75, 8, 0 op_sel:[1,0,0,0]
  ds_read_b64 v[40:41], v40
  ds_read_b64 v[42:43], v42
  ds_read_b64 v[44:45], v44
  ds_read_b64 v[46:47], v46
  s_waitcnt lgkmcnt(12)
  v_smfmac_f32_16x16x64_bf16 v[12:15], v[8:11], v[32:39], v7
ga_p4:
  v_mad_u32_u16 v32, v72, 8, 0 op_sel:[0,0,0,0]
  v_mad_u32_u16 v34, v72, 8, 0 op_sel:[1,0,0,0]
  v_mad_u32_u16 v36, v73, 8, 0 op_sel:[0,0,0,0]
  v_mad_u32_u16 v38, v73, 8, 0 op_sel:[1,0,0,0]
  ds_read_b64 v[32:33], v32
  ds_read_b64 v[34:35], v34
  ds_read_b64 v[36:37], v36
  ds_read_b64 v[38:39], v38
  s_waitcnt lgkmcnt(12)
  v_smfmac_f32_16x16x64_bf16 v[12:15], v[8:11], v[56:63], v7
ga_p3:
  v_mad_u32_u16 v56, v70, 8, 0 op_sel:[0,0,0,0]
  v_mad_u32_u16 v58, v70, 8, 0 op_sel:[1,0,0,0]
  v_mad_u32_u16 v60, v71, 8, 0 op_sel:[0,0,0,0]
  v_mad_u32_u16 v62, v71, 8, 0 op_sel:[1,0,0,0]
  ds_read_b64 v[56:57], v56
  ds_read_b64 v[58:59], v58
  ds_read_b64 v[60:61], v60
  ds_read_b64 v[62:63], v62
  s_waitcnt lgkmcnt(12)
  v_smfmac_f32_16x16x64_bf16 v[12:15], v[8:11], v[48:55], v7
ga_p2:
  v_mad_u32_u16 v48, v68, 8, 0 op_sel:[0,0,0,0]
  v_mad_u32_u16 v50, v68, 8, 0 op_sel:[1,0,0,0]
  v_mad_u32_u16 v52, v69, 8, 0 op_sel:[0,0,0,0]
  v_mad_u32_u16 v54, v69, 8, 0 op_sel:[1,0,0,0]
  ds_read_b64 v[48:49], v48
  ds_read_b64 v[50:51], v50
  ds_read_b64 v[52:53], v52
  ds_read_b64 v[54:55], v54
  s_waitcnt lgkmcnt(12)
  v_smfmac_f32_16x16x64_bf16 v[12:15], v[8:11], v[40:47], v7
ga_p1:
  s_cmp_eq_u32 s13, 0
  s_cbranch_scc1 ga_dr
  v_mad_u32_u16 v40, v66, 8, 0 op_sel:[0,0,0,0]
  v_mad_u32_u16 v42, v66, 8, 0 op_sel:[1,0,0,0]
  v_mad_u32_u16 v44, v67, 8, 0 op_sel:[0,0,0,0]
  v_mad_u32_u16 v46, v67, 8, 0 op_sel:[1,0,0,0]
  ds_read_b64 v[40:41], v40
  ds_read_b64 v[42:43], v42
  ds_read_b64 v[44:45], v44
  ds_read_b64 v[46:47], v46
  s_waitcnt lgkmcnt(12)
  v_smfmac_f32_16x16x64_bf16 v[12:15], v[8:11], v[32:39], v7
ga_p0:
  v_mad_u32_u16 v32, v64, 8, 0 op_sel:[0,0,0,0]
  v_mad_u32_u16 v34, v64, 8, 0 op_sel:[1,0,0,0]
  v_mad_u32_u16 v36, v65, 8, 0 op_sel:[0,0,0,0]
  v_mad_u32_u16 v38, v65, 8, 0 op_sel:[1,0,0,0]
  ds_read_b64 v[32:33], v32
  ds_read_b64 v[34:35], v34
  ds_read_b64 v[36:37], v36
  ds_read_b64 v[38:39], v38
  s_waitcnt lgkmcnt(12)
  v_smfmac_f32_16x16x64_bf16 v[12:15], v[8:11], v[56:63], v7
  s_waitcnt lgkmcnt(8)
  v_smfmac_f32_16x16x64_bf16 v[12:15], v[8:11], v[48:55], v7
  s_waitcnt lgkmcnt(4)
  v_smfmac_f32_16x16x64_bf16 v[12:15], v[8:11], v[40:47], v7
  s_waitcnt lgkmcnt(0)
  v_smfmac_f32_16x16x64_bf16 v[12:15], v[8:11], v[32:39], v7
ga_dd:
  s_nop 7
  s_cmp_lg_u32 s18, 0
  s_cbranch_scc1 ga_ovf
ga_fin:
  s_nop 1
  v_mul_f32 v20, v12, v16
  v_mul_f32 v21, v13, v16
  v_mul_f32 v22, v14, v16
  v_mul_f32 v23, v15, v16
  v_cvt_pk_bf16_f32 v24, v20, v21
  v_cvt_pk_bf16_f32 v25, v22, v23
  v_mul_f32 v20, v20, v16
  v_mul_f32 v22, v22, v16
  v_mul_f32 v23, v23, v16
  v_add_u32 v20, s26, v20
  v_mul_f32 v21, v21, v16
  v_and_b32 v20, 0xfffe0000, v20
  v_cvt_pk_bf16_f32 v29, v22, v23
  v_cvt_pk_bf16_f32 v28, v20, v21
  v_or_b32 v28, s8, v28
  s_mov_b64 vcc, s[32:33]
  v_cndmask_b32_dpp v21, v25, v29, vcc quad_perm:[1,0,3,2] row_mask:0xf bank_mask:0xf
  v_cndmask_b32_dpp v20, v24, v28, vcc quad_perm:[1,0,3,2] row_mask:0xf bank_mask:0xf
  s_mov_b64 vcc, s[34:35]
  v_cndmask_b32_dpp v23, v29, v25, vcc quad_perm:[1,0,3,2] row_mask:0xf bank_mask:0xf
  v_cndmask_b32_dpp v22, v28, v24, vcc quad_perm:[1,0,3,2] row_mask:0xf bank_mask:0xf
  s_cmp_eq_u32 s24, 6
  s_cbranch_scc1 ga_hs
  s_mov_b64 exec, s[32:33]
  global_store_dwordx4 v18, v[20:23], s[6:7]
  s_cmp_ge_u32 s12, 9
  s_cbranch_scc1 h_poll
ga_hs:
  s_mov_b64 exec, s[34:35]
  global_store_dwordx4 v18, v[20:23], s[28:29] sc1
  s_mov_b64 exec, -1
  s_cmp_eq_u32 s15, 0
  s_cbranch_scc1 h_nob
  s_setprio 0
  s_waitcnt vmcnt(2)
  s_cmp_eq_u32 s20, 48
  s_cbranch_scc1 gb_e12
  s_cmp_eq_u32 s20, 44
  s_cbranch_scc1 gb_e11
  s_cmp_eq_u32 s20, 52
  s_cbranch_scc1 gb_e13
  s_cmp_eq_u32 s20, 40
  s_cbranch_scc1 gb_e10
  s_cmp_eq_u32 s20, 56
  s_cbranch_scc1 gb_e14
  s_cmp_eq_u32 s20, 36
  s_cbranch_scc1 gb_e9
  s_cmp_eq_u32 s20, 60
  s_cbranch_scc1 gb_e15
  s_cmp_eq_u32 s20, 32
  s_cbranch_scc1 gb_e8
  v_mad_u32_u16 v56, v126, 8, 0 op_sel:[0,0,0,0]
  v_mad_u32_u16 v58, v126, 8, 0 op_sel:[1,0,0,0]
  v_mad_u32_u16 v60, v127, 8, 0 op_sel:[0,0,0,0]
  v_mad_u32_u16 v62, v127, 8, 0 op_sel:[1,0,0,0]
  ds_read_b64 v[56:57], v56
  ds_read_b64 v[58:59], v58
  ds_read_b64 v[60:61], v60
  ds_read_b64 v[62:63], v62
  v_mad_u32_u16 v48, v124, 8, 0 op_sel:[0,0,0,0]
  v_mad_u32_u16 v50, v124, 8, 0 op_sel:[1,0,0,0]
  v_mad_u32_u16 v52, v125, 8, 0 op_sel:[0,0,0,0]
  v_mad_u32_u16 v54, v125, 8, 0 op_sel:[1,0,0,0]
  ds_read_b64 v[48:49], v48
  ds_read_b64 v[50:51], v50
  ds_read_b64 v[52:53], v52
  ds_read_b64 v[54:55], v54
  v_mad_u32_u16 v40, v122, 8, 0 op_sel:[0,0,0,0]
  v_mad_u32_u16 v42, v122, 8, 0 op_sel:[1,0,0,0]
  v_mad_u32_u16 v44, v123, 8, 0 op_sel:[0,0,0,0]
  v_mad_u32_u16 v46, v123, 8, 0 op_sel:[1,0,0,0]
  ds_read_b64 v[40:41], v40
  ds_read_b64 v[42:43], v42
  ds_read_b64 v[44:45], v44
  ds_read_b64 v[46:47], v46
  s_branch gb_p12
gb_e12:
  v_mad_u32_u16 v56, v118, 8, 0 op_sel:[0,0,0,0]
  v_mad_u32_u16 v58, v118, 8, 0 op_sel:[1,0,0,0]
  v_mad_u32_u16 v60, v119, 8, 0 op_sel:[0,0,0,0]
  v_mad_u32_u16 v62, v119, 8, 0 op_sel:[1,0,0,0]
  ds_read_b64 v[56:57], v56
  ds_read_b64 v[58:59], v58
  ds_read_b64 v[60:61], v60
  ds_read_b64 v[62:63], v62
  v_mad_u32_u16 v48, v116, 8, 0 op_sel:[0,0,0,0]
  v_mad_u32_u16 v50, v116, 8, 0 op_sel:[1,0,0,0]
  v_mad_u32_u16 v52, v117, 8, 0 op_sel:[0,0,0,0]
  v_mad_u32_u16 v54, v117, 8, 0 op_sel:[1,0,0,0]
  ds_read_b64 v[48:49], v48
  ds_read_b64 v[50:51], v50
  ds_read_b64 v[52:53], v52
  ds_read_b64 v[54:55], v54
  v_mad_u32_u16 v40, v114, 8, 0 op_sel:[0,0,0,0]
  v_mad_u32_u16 v42, v114, 8, 0 op_sel:[1,0,0,0]
  v_mad_u32_u16 v44, v115, 8, 0 op_sel:[0,0,0,0]
  v_mad_u32_u16 v46, v115, 8, 0 op_sel:[1,0,0,0]
  ds_read_b64 v[40:41], v40
  ds_read_b64 v[42:43], v42
  ds_read_b64 v[44:45], v44
  ds_read_b64 v[46:47], v46
  s_branch gb_p8
gb_e11:
  v_mad_u32_u16 v48, v116, 8, 0 op_sel:[0,0,0,0]
  v_mad_u32_u16 v50, v116, 8, 0 op_sel:[1,0,0,0]
  v_mad_u32_u16 v52, v117, 8, 0 op_sel:[0,0,0,0]
  v_mad_u32_u16 v54, v117, 8, 0 op_sel:[1,0,0,0]
  ds_read_b64 v[48:49], v48
  ds_read_b64 v[50:51], v50
  ds_read_b64 v[52:53], v52
  ds_read_b64 v[54:55], v54
  v_mad_u32_u16 v40, v114, 8, 0 op_sel:[0,0,0,0]
  v_mad_u32_u16 v42, v114, 8, 0 op_sel:[1,0,0,0]
  v_mad_u32_u16 v44, v115, 8, 0 op_sel:[0,0,0,0]
  v_mad_u32_u16 v46, v115, 8, 0 op_sel:[1,0,0,0]
  ds_read_b64 v[40:41], v40
  ds_read_b64 v[42:43], v42
  ds_read_b64 v[44:45], v44
  ds_read_b64 v[46:47], v46
  v_mad_u32_u16 v32, v112, 8, 0 op_sel:[0,0,0,0]
  v_mad_u32_u16 v34, v112, 8, 0 op_sel:[1,0,0,0]
  v_mad_u32_u16 v36, v113, 8, 0 op_sel:[0,0,0,0]
  v_mad_u32_u16 v38, v113, 8, 0 op_sel:[1,0,0,0]
  ds_read_b64 v[32:33], v32
  ds_read_b64 v[34:35], v34
  ds_read_b64 v[36:37], v36
  ds_read_b64 v[38:39], v38
  s_branch gb_p7
gb_e13:
  v_mad_u32_u16 v32, v120, 8, 0 op_sel:[0,0,0,0]
  v_mad_u32_u16 v34, v120, 8, 0 op_sel:[1,0,0,0]
  v_mad_u32_u16 v36, v121, 8, 0 op_sel:[0,0,0,0]
  v_mad_u32_u16 v38, v121, 8, 0 op_sel:[1,0,0,0]
  ds_read_b64 v[32:33], v32
  ds_read_b64 v[34:35], v34
  ds_read_b64 v[36:37], v36
  ds_read_b64 v[38:39], v38
  v_mad_u32_u16 v56, v118, 8, 0 op_sel:[0,0,0,0]
  v_mad_u32_u16 v58, v118, 8, 0 op_sel:[1,0,0,0]
  v_mad_u32_u16 v60, v119, 8, 0 op_sel:[0,0,0,0]
  v_mad_u32_u16 v62, v119, 8, 0 op_sel:[1,0,0,0]
  ds_read_b64 v[56:57], v56
  ds_read_b64 v[58:59], v58
  ds_read_b64 v[60:61], v60
  ds_read_b64 v[62:63], v62
  v_mad_u32_u16 v48, v116, 8, 0 op_sel:[0,0,0,0]
  v_mad_u32_u16 v50, v116, 8, 0 op_sel:[1,0,0,0]
  v_mad_u32_u16 v52, v117, 8, 0 op_sel:[0,0,0,0]
  v_mad_u32_u16 v54, v117, 8, 0 op_sel:[1,0,0,0]
  ds_read_b64 v[48:49], v48
  ds_read_b64 v[50:51], v50
  ds_read_b64 v[52:53], v52
  ds_read_b64 v[54:55], v54
  s_branch gb_p9
gb_e10:
  v_mad_u32_u16 v40, v114, 8, 0 op_sel:[0,0,0,0]
  v_mad_u32_u16 v42, v114, 8, 0 op_sel:[1,0,0,0]
  v_mad_u32_u16 v44, v115, 8, 0 op_sel:[0,0,0,0]
  v_mad_u32_u16 v46, v115, 8, 0 op_sel:[1,0,0,0]
  ds_read_b64 v[40:41], v40
  ds_read_b64 v[42:43], v42
  ds_read_b64 v[44:45], v44
  ds_read_b64 v[46:47], v46
  v_mad_u32_u16 v32, v112, 8, 0 op_sel:[0,0,0,0]
  v_mad_u32_u16 v34, v112, 8, 0 op_sel:[1,0,0,0]
  v_mad_u32_u16 v36, v113, 8, 0 op_sel:[0,0,0,0]
  v_mad_u32_u16 v38, v113, 8, 0 op_sel:[1,0,0,0]
  ds_read_b64 v[32:33], v32
  ds_read_b64 v[34:35], v34
  ds_read_b64 v[36:37], v36
  ds_read_b64 v[38:39], v38
  v_mad_u32_u16 v56, v110, 8, 0 op_sel:[0,0,0,0]
  v_mad_u32_u16 v58, v110, 8, 0 op_sel:[1,0,0,0]
  v_mad_u32_u16 v60, v111, 8, 0 op_sel:[0,0,0,0]
  v_mad_u32_u16 v62, v111, 8, 0 op_sel:[1,0,0,0]
  ds_read_b64 v[56:57], v56
  ds_read_b64 v[58:59], v58
  ds_read_b64 v[60:61], v60
  ds_read_b64 v[62:63], v62
  s_branch gb_p6
gb_e14:
  v_mad_u32_u16 v40, v122, 8, 0 op_sel:[0,0,0,0]
  v_mad_u32_u16 v42, v122, 8, 0 op_sel:[1,0,0,0]
  v_mad_u32_u16 v44, v123, 8, 0 op_sel:[0,0,0,0]
  v_mad_u32_u16 v46, v123, 8, 0 op_sel:[1,0,0,0]
  ds_read_b64 v[40:41], v40
  ds_read_b64 v[42:43], v42
  ds_read_b64 v[44:45], v44
  ds_read_b64 v[46:47], v46
  v_mad_u32_u16 v32, v120, 8, 0 op_sel:[0,0,0,0]
  v_mad_u32_u16 v34, v120, 8, 0 op_sel:[1,0,0,0]
  v_mad_u32_u16 v36, v121, 8, 0 op_sel:[0,0,0,0]
  v_mad_u32_u16 v38, v121, 8, 0 op_sel:[1,0,0,0]
  ds_read_b64 v[32:33], v32
  ds_read_b64 v[34:35], v34
  ds_read_b64 v[36:37], v36
  ds_read_b64 v[38:39], v38
  v_mad_u32_u16 v56, v118, 8, 0 op_sel:[0,0,0,0]
  v_mad_u32_u16 v58, v118, 8, 0 op_sel:[1,0,0,0]
  v_mad_u32_u16 v60, v119, 8, 0 op_sel:[0,0,0,0]
  v_mad_u32_u16 v62, v119, 8, 0 op_sel:[1,0,0,0]
  ds_read_b64 v[56:57], v56
  ds_read_b64 v[58:59], v58
  ds_read_b64 v[60:61], v60
  ds_read_b64 v[62:63], v62
  s_branch gb_p10
gb_e9:
  v_mad_u32_u16 v32, v112, 8, 0 op_sel:[0,0,0,0]
  v_mad_u32_u16 v34, v112, 8, 0 op_sel:[1,0,0,0]
  v_mad_u32_u16 v36, v113, 8, 0 op_sel:[0,0,0,0]
  v_mad_u32_u16 v38, v113, 8, 0 op_sel:[1,0,0,0]
  ds_read_b64 v[32:33], v32
  ds_read_b64 v[34:35], v34
  ds_read_b64 v[36:37], v36
  ds_read_b64 v[38:39], v38
  v_mad_u32_u16 v56, v110, 8, 0 op_sel:[0,0,0,0]
  v_mad_u32_u16 v58, v110, 8, 0 op_sel:[1,0,0,0]
  v_mad_u32_u16 v60, v111, 8, 0 op_sel:[0,0,0,0]
  v_mad_u32_u16 v62, v111, 8, 0 op_sel:[1,0,0,0]
  ds_read_b64 v[56:57], v56
  ds_read_b64 v[58:59], v58
  ds_read_b64 v[60:61], v60
  ds_read_b64 v[62:63], v62
  v_mad_u32_u16 v48, v108, 8, 0 op_sel:[0,0,0,0]
  v_mad_u32_u16 v50, v108, 8, 0 op_sel:[1,0,0,0]
  v_mad_u32_u16 v52, v109, 8, 0 op_sel:[0,0,0,0]
  v_mad_u32_u16 v54, v109, 8, 0 op_sel:[1,0,0,0]
  ds_read_b64 v[48:49], v48
  ds_read_b64 v[50:51], v50
  ds_read_b64 v[52:53], v52
  ds_read_b64 v[54:55], v54
  s_branch gb_p5
gb_e15:
  v_mad_u32_u16 v48, v124, 8, 0 op_sel:[0,0,0,0]
  v_mad_u32_u16 v50, v124, 8, 0 op_sel:[1,0,0,0]
  v_mad_u32_u16 v52, v125, 8, 0 op_sel:[0,0,0,0]
  v_mad_u32_u16 v54, v125, 8, 0 op_sel:[1,0,0,0]
  ds_read_b64 v[48:49], v48
  ds_read_b64 v[50:51], v50
  ds_read_b64 v[52:53], v52
  ds_read_b64 v[54:55], v54
  v_mad_u32_u16 v40, v122, 8, 0 op_sel:[0,0,0,0]
  v_mad_u32_u16 v42, v122, 8, 0 op_sel:[1,0,0,0]
  v_mad_u32_u16 v44, v123, 8, 0 op_sel:[0,0,0,0]
  v_mad_u32_u16 v46, v123, 8, 0 op_sel:[1,0,0,0]
  ds_read_b64 v[40:41], v40
  ds_read_b64 v[42:43], v42
  ds_read_b64 v[44:45], v44
  ds_read_b64 v[46:47], v46
  v_mad_u32_u16 v32, v120, 8, 0 op_sel:[0,0,0,0]
  v_mad_u32_u16 v34, v120, 8, 0 op_sel:[1,0,0,0]
  v_mad_u32_u16 v36, v121, 8, 0 op_sel:[0,0,0,0]
  v_mad_u32_u16 v38, v121, 8, 0 op_sel:[1,0,0,0]
  ds_read_b64 v[32:33], v32
  ds_read_b64 v[34:35], v34
  ds_read_b64 v[36:37], v36
  ds_read_b64 v[38:39], v38
  s_branch gb_p11
gb_e8:
  v_mad_u32_u16 v56, v110, 8, 0 op_sel:[0,0,0,0]
  v_mad_u32_u16 v58, v110, 8, 0 op_sel:[1,0,0,0]
  v_mad_u32_u16 v60, v111, 8, 0 op_sel:[0,0,0,0]
  v_mad_u32_u16 v62, v111, 8, 0 op_sel:[1,0,0,0]
  ds_read_b64 v[56:57], v56
  ds_read_b64 v[58:59], v58
  ds_read_b64 v[60:61], v60
  ds_read_b64 v[62:63], v62
  v_mad_u32_u16 v48, v108, 8, 0 op_sel:[0,0,0,0]
  v_mad_u32_u16 v50, v108, 8, 0 op_sel:[1,0,0,0]
  v_mad_u32_u16 v52, v109, 8, 0 op_sel:[0,0,0,0]
  v_mad_u32_u16 v54, v109, 8, 0 op_sel:[1,0,0,0]
  ds_read_b64 v[48:49], v48
  ds_read_b64 v[50:51], v50
  ds_read_b64 v[52:53], v52
  ds_read_b64 v[54:55], v54
  v_mad_u32_u16 v40, v106, 8, 0 op_sel:[0,0,0,0]
  v_mad_u32_u16 v42, v106, 8, 0 op_sel:[1,0,0,0]
  v_mad_u32_u16 v44, v107, 8, 0 op_sel:[0,0,0,0]
  v_mad_u32_u16 v46, v107, 8, 0 op_sel:[1,0,0,0]
  ds_read_b64 v[40:41], v40
  ds_read_b64 v[42:43], v42
  ds_read_b64 v[44:45], v44
  ds_read_b64 v[46:47], v46
  s_branch gb_p4
gb_dr:
  s_waitcnt lgkmcnt(8)
  v_smfmac_f32_16x16x64_bf16 v[2:5], v[8:11], v[32:39], v7
  s_waitcnt lgkmcnt(4)
  v_smfmac_f32_16x16x64_bf16 v[2:5], v[8:11], v[56:63], v7
  s_waitcnt lgkmcnt(0)
  v_smfmac_f32_16x16x64_bf16 v[2:5], v[8:11], v[48:55], v7
  s_branch gb_dd
gb_p12:
  v_mad_u32_u16 v32, v120, 8, 0 op_sel:[0,0,0,0]
  v_mad_u32_u16 v34, v120, 8, 0 op_sel:[1,0,0,0]
  v_mad_u32_u16 v36, v121, 8, 0 op_sel:[0,0,0,0]
  v_mad_u32_u16 v38, v121, 8, 0 op_sel:[1,0,0,0]
  ds_read_b64 v[32:33], v32
  ds_read_b64 v[34:35], v34
  ds_read_b64 v[36:37], v36
  ds_read_b64 v[38:39], v38
  s_waitcnt lgkmcnt(12)
  v_smfmac_f32_16x16x64_bf16 v[2:5], v[8:11], v[56:63], v7
gb_p11:
  v_mad_u32_u16 v56, v118, 8, 0 op_sel:[0,0,0,0]
  v_mad_u32_u16 v58, v118, 8, 0 op_sel:[1,0,0,0]
  v_mad_u32_u16 v60, v119, 8, 0 op_sel:[0,0,0,0]
  v_mad_u32_u16 v62, v119, 8, 0 op_sel:[1,0,0,0]
  ds_read_b64 v[56:57], v56
  ds_read_b64 v[58:59], v58
  ds_read_b64 v[60:61], v60
  ds_read_b64 v[62:63], v62
  s_waitcnt lgkmcnt(12)
  v_smfmac_f32_16x16x64_bf16 v[2:5], v[8:11], v[48:55], v7
gb_p10:
  v_mad_u32_u16 v48, v116, 8, 0 op_sel:[0,0,0,0]
  v_mad_u32_u16 v50, v116, 8, 0 op_sel:[1,0,0,0]
  v_mad_u32_u16 v52, v117, 8, 0 op_sel:[0,0,0,0]
  v_mad_u32_u16 v54, v117, 8, 0 op_sel:[1,0,0,0]
  ds_read_b64 v[48:49], v48
  ds_read_b64 v[50:51], v50
  ds_read_b64 v[52:53], v52
  ds_read_b64 v[54:55], v54
  s_waitcnt lgkmcnt(12)
  v_smfmac_f32_16x16x64_bf16 v[2:5], v[8:11], v[40:47], v7
gb_p9:
  v_mad_u32_u16 v40, v114, 8, 0 op_sel:[0,0,0,0]
  v_mad_u32_u16 v42, v114, 8, 0 op_sel:[1,0,0,0]
  v_mad_u32_u16 v44, v115, 8, 0 op_sel:[0,0,0,0]
  v_mad_u32_u16 v46, v115, 8, 0 op_sel:[1,0,0,0]
  ds_read_b64 v[40:41], v40
  ds_read_b64 v[42:43], v42
  ds_read_b64 v[44:45], v44
  ds_read_b64 v[46:47], v46
  s_waitcnt lgkmcnt(12)
  v_smfmac_f32_16x16x64_bf16 v[2:5], v[8:11], v[32:39], v7
gb_p8:
  v_mad_u32_u16 v32, v112, 8, 0 op_sel:[0,0,0,0]
  v_mad_u32_u16 v34, v112, 8, 0 op_sel:[1,0,0,0]
  v_mad_u32_u16 v36, v113, 8, 0 op_sel:[0,0,0,0]
  v_mad_u32_u16 v38, v113, 8, 0 op_sel:[1,0,0,0]
  ds_read_b64 v[32:33], v32
  ds_read_b64 v[34:35], v34
  ds_read_b64 v[36:37], v36
  ds_read_b64 v[38:39], v38
  s_waitcnt lgkmcnt(12)
  v_smfmac_f32_16x16x64_bf16 v[2:5], v[8:11], v[56:63], v7
gb_p7:
  v_mad_u32_u16 v56, v110, 8, 0 op_sel:[0,0,0,0]
  v_mad_u32_u16 v58, v110, 8, 0 op_sel:[1,0,0,0]
  v_mad_u32_u16 v60, v111, 8, 0 op_sel:[0,0,0,0]
  v_mad_u32_u16 v62, v111, 8, 0 op_sel:[1,0,0,0]
  ds_read_b64 v[56:57], v56
  ds_read_b64 v[58:59], v58
  ds_read_b64 v[60:61], v60
  ds_read_b64 v[62:63], v62
  s_waitcnt lgkmcnt(12)
  v_smfmac_f32_16x16x64_bf16 v[2:5], v[8:11], v[48:55], v7
gb_p6:
  v_mad_u32_u16 v48, v108, 8, 0 op_sel:[0,0,0,0]
  v_mad_u32_u16 v50, v108, 8, 0 op_sel:[1,0,0,0]
  v_mad_u32_u16 v52, v109, 8, 0 op_sel:[0,0,0,0]
  v_mad_u32_u16 v54, v109, 8, 0 op_sel:[1,0,0,0]
  ds_read_b64 v[48:49], v48
  ds_read_b64 v[50:51], v50
  ds_read_b64 v[52:53], v52
  ds_read_b64 v[54:55], v54
  s_waitcnt lgkmcnt(12)
  v_smfmac_f32_16x16x64_bf16 v[2:5], v[8:11], v[40:47], v7
gb_p5:
  v_mad_u32_u16 v40, v106, 8, 0 op_sel:[0,0,0,0]
  v_mad_u32_u16 v42, v106, 8, 0 op_sel:[1,0,0,0]
  v_mad_u32_u16 v44, v107, 8, 0 op_sel:[0,0,0,0]
  v_mad_u32_u16 v46, v107, 8, 0 op_sel:[1,0,0,0]
  ds_read_b64 v[40:41], v40
  ds_read_b64 v[42:43], v42
  ds_read_b64 v[44:45], v44
  ds_read_b64 v[46:47], v46
  s_waitcnt lgkmcnt(12)
  v_smfmac_f32_16x16x64_bf16 v[2:5], v[8:11], v[32:39], v7
gb_p4:
  v_mad_u32_u16 v32, v104, 8, 0 op_sel:[0,0,0,0]
  v_mad_u32_u16 v34, v104, 8, 0 op_sel:[1,0,0,0]
  v_mad_u32_u16 v36, v105, 8, 0 op_sel:[0,0,0,0]
  v_mad_u32_u16 v38, v105, 8, 0 op_sel:[1,0,0,0]
  ds_read_b64 v[32:33], v32
  ds_read_b64 v[34:35], v34
  ds_read_b64 v[36:37], v36
  ds_read_b64 v[38:39], v38
  s_waitcnt lgkmcnt(12)
  v_smfmac_f32_16x16x64_bf16 v[2:5], v[8:11], v[56:63], v7
gb_p3:
  v_mad_u32_u16 v56, v102, 8, 0 op_sel:[0,0,0,0]
  v_mad_u32_u16 v58, v102, 8, 0 op_sel:[1,0,0,0]
  v_mad_u32_u16 v60, v103, 8, 0 op_sel:[0,0,0,0]
  v_mad_u32_u16 v62, v103, 8, 0 op_sel:[1,0,0,0]
  ds_read_b64 v[56:57], v56
  ds_read_b64 v[58:59], v58
  ds_read_b64 v[60:61], v60
  ds_read_b64 v[62:63], v62
  s_waitcnt lgkmcnt(12)
  v_smfmac_f32_16x16x64_bf16 v[2:5], v[8:11], v[48:55], v7
gb_p2:
  v_mad_u32_u16 v48, v100, 8, 0 op_sel:[0,0,0,0]
  v_mad_u32_u16 v50, v100, 8, 0 op_sel:[1,0,0,0]
  v_mad_u32_u16 v52, v101, 8, 0 op_sel:[0,0,0,0]
  v_mad_u32_u16 v54, v101, 8, 0 op_sel:[1,0,0,0]
  ds_read_b64 v[48:49], v48
  ds_read_b64 v[50:51], v50
  ds_read_b64 v[52:53], v52
  ds_read_b64 v[54:55], v54
  s_waitcnt lgkmcnt(12)
  v_smfmac_f32_16x16x64_bf16 v[2:5], v[8:11], v[40:47], v7
gb_p1:
  s_cmp_eq_u32 s14, 0
  s_cbranch_scc1 gb_dr
  v_mad_u32_u16 v40, v98, 8, 0 op_sel:[0,0,0,0]
  v_mad_u32_u16 v42, v98, 8, 0 op_sel:[1,0,0,0]
  v_mad_u32_u16 v44, v99, 8, 0 op_sel:[0,0,0,0]
  v_mad_u32_u16 v46, v99, 8, 0 op_sel:[1,0,0,0]
  ds_read_b64 v[40:41], v40
  ds_read_b64 v[42:43], v42
  ds_read_b64 v[44:45], v44
  ds_read_b64 v[46:47], v46
  s_waitcnt lgkmcnt(12)
  v_smfmac_f32_16x16x64_bf16 v[2:5], v[8:11], v[32:39], v7
gb_p0:
  v_mad_u32_u16 v32, v96, 8, 0 op_sel:[0,0,0,0]
  v_mad_u32_u16 v34, v96, 8, 0 op_sel:[1,0,0,0]
  v_mad_u32_u16 v36, v97, 8, 0 op_sel:[0,0,0,0]
  v_mad_u32_u16 v38, v97, 8, 0 op_sel:[1,0,0,0]
  ds_read_b64 v[32:33], v32
  ds_read_b64 v[34:35], v34
  ds_read_b64 v[36:37], v36
  ds_read_b64 v[38:39], v38
  s_waitcnt lgkmcnt(12)
  v_smfmac_f32_16x16x64_bf16 v[2:5], v[8:11], v[56:63], v7
  s_waitcnt lgkmcnt(8)
  v_smfmac_f32_16x16x64_bf16 v[2:5], v[8:11], v[48:55], v7
  s_waitcnt lgkmcnt(4)
  v_smfmac_f32_16x16x64_bf16 v[2:5], v[8:11], v[40:47], v7
  s_waitcnt lgkmcnt(0)
  v_smfmac_f32_16x16x64_bf16 v[2:5], v[8:11], v[32:39], v7
gb_dd:
  s_nop 7
  s_cmp_lg_u32 s22, 0
  s_cbranch_scc1 gb_ovf
gb_fin:
  s_nop 1
  v_mul_f32 v20, v2, v17
  v_mul_f32 v21, v3, v17
  v_mul_f32 v22, v4, v17
  v_mul_f32 v23, v5, v17
  v_cvt_pk_bf16_f32 v24, v20, v21
  v_cvt_pk_bf16_f32 v25, v22, v23
  v_mul_f32 v20, v20, v17
  v_mul_f32 v22, v22, v17
  v_mul_f32 v23, v23, v17
  v_add_u32 v20, s26, v20
  v_mul_f32 v21, v21, v17
  v_and_b32 v20, 0xfffe0000, v20
  v_cvt_pk_bf16_f32 v27, v22, v23
  v_cvt_pk_bf16_f32 v26, v20, v21
  v_or_b32 v26, s8, v26
  s_mov_b64 vcc, s[32:33]
  v_cndmask_b32_dpp v21, v25, v27, vcc quad_perm:[1,0,3,2] row_mask:0xf bank_mask:0xf
  v_cndmask_b32_dpp v20, v24, v26, vcc quad_perm:[1,0,3,2] row_mask:0xf bank_mask:0xf
  s_mov_b64 vcc, s[34:35]
  v_cndmask_b32_dpp v23, v27, v25, vcc quad_perm:[1,0,3,2] row_mask:0xf bank_mask:0xf
  v_cndmask_b32_dpp v22, v26, v24, vcc quad_perm:[1,0,3,2] row_mask:0xf bank_mask:0xf
  s_cmp_eq_u32 s24, 6
  s_cbranch_scc1 gb_hs
  s_mov_b64 exec, s[32:33]
  global_store_dwordx4 v19, v[20:23], s[6:7]
gb_hs:
  s_mov_b64 exec, s[34:35]
  global_store_dwordx4 v19, v[20:23], s[28:29] sc1
  s_mov_b64 exec, -1
  s_cmp_eq_u32 s24, 6
  s_cbranch_scc1 h_end
  s_barrier
  ds_write_b64 v0, v[28:29]
  ds_write_b64 v0, v[26:27] offset:8192
  s_branch h_next
h_nob:
  s_cmp_eq_u32 s24, 6
  s_cbranch_scc1 h_last
  s_barrier
  ds_write_b64 v0, v[28:29]
  s_branch h_next
h_poll:
  s_setprio 3
  s_mov_b64 exec, -1
  s_mov_b64 s[40:41], -1
  s_mov_b64 s[42:43], -1
  s_mov_b64 s[44:45], -1
  s_mov_b64 s[46:47], -1
  s_mov_b32 s48, s31
  s_mov_b32 s49, 0
  s_mov_b32 s58, 31
h_pe0:
  global_load_dwordx4 v[32:35], v2, s[6:7] offset:-4096 sc1
  global_load_dwordx4 v[36:39], v2, s[6:7] offset:-3072 sc1
  global_load_dwordx4 v[40:43], v2, s[6:7] offset:-2048 sc1
  global_load_dwordx4 v[44:47], v2, s[6:7] offset:-1024 sc1
h_pc0:
  s_waitcnt vmcnt(3)
  v_bitop3_b32 v6, v32, v34, s8 bitop3:0x7e
  s_waitcnt vmcnt(2)
  v_bitop3_b32 v30, v36, v38, s8 bitop3:0x7e
  s_waitcnt vmcnt(1)
  v_bitop3_b32 v31, v40, v42, s8 bitop3:0x7e
  v_or3_b32 v6, v6, v30, v31
  s_waitcnt vmcnt(0)
  v_bitop3_b32 v30, v44, v46, s8 bitop3:0x7e
  v_bitop3_b32 v6, v6, v30, 1 bitop3:0xa8
  v_cmp_ne_u32 vcc, 0, v6
  s_and_b64 exec, vcc, vcc
  s_cbranch_scc0 h_ped0
  s_sub_u32 s58, s58, 1
  s_cbranch_scc0 h_pe0
  buffer_wbl2 sc1
  s_mov_b32 s58, 31
  s_sub_u32 s30, s30, 1
  s_cbranch_scc0 h_pe0
  s_mov_b32 s30, 0
h_ped0:
  s_mov_b64 exec, -1
  s_barrier
  global_load_dwordx4 v[48:51], v2, s[6:7] offset:0 sc1
  global_load_dwordx4 v[52:55], v2, s[6:7] offset:1024 sc1
  global_load_dwordx4 v[56:59], v2, s[6:7] offset:2048 sc1
  global_load_dwordx4 v[60:63], v2, s[6:7] offset:3072 sc1
  ds_write_b128 v3, v[32:35] offset:0
  ds_write_b128 v3, v[36:39] offset:1024
  ds_write_b128 v3, v[40:43] offset:2048
  ds_write_b128 v3, v[44:47] offset:3072
  ds_write_b64 v0, v[28:29]
  s_branch h_pc1
h_pe1:
  global_load_dwordx4 v[48:51], v2, s[6:7] offset:0 sc1
  global_load_dwordx4 v[52:55], v2, s[6:7] offset:1024 sc1
  global_load_dwordx4 v[56:59], v2, s[6:7] offset:2048 sc1
  global_load_dwordx4 v[60:63], v2, s[6:7] offset:3072 sc1
h_pc1:
  s_waitcnt vmcnt(3)
  v_bitop3_b32 v6, v48, v50, s8 bitop3:0x7e
  s_waitcnt vmcnt(2)
  v_bitop3_b32 v30, v52, v54, s8 bitop3:0x7e
  s_waitcnt vmcnt(1)
  v_bitop3_b32 v31, v56, v58, s8 bitop3:0x7e
  v_or3_b32 v6, v6, v30, v31
  s_waitcnt vmcnt(0)
  v_bitop3_b32 v30, v60, v62, s8 bitop3:0x7e
  v_bitop3_b32 v6, v6, v30, 1 bitop3:0xa8
  v_cmp_ne_u32 vcc, 0, v6
  s_and_b64 exec, vcc, vcc
  s_cbranch_scc0 h_ped1
  s_sub_u32 s58, s58, 1
  s_cbranch_scc0 h_pe1
  buffer_wbl2 sc1
  s_mov_b32 s58, 31
  s_sub_u32 s30, s30, 1
  s_cbranch_scc0 h_pe1
  s_mov_b32 s30, 0
h_ped1:
  s_mov_b64 exec, -1
  global_load_dwordx4 v[96:99], v19, s[6:7] offset:-4096 sc1
  global_load_dwordx4 v[100:103], v19, s[6:7] offset:-3072 sc1
  global_load_dwordx4 v[104:107], v19, s[6:7] offset:-2048 sc1
  global_load_dwordx4 v[108:111], v19, s[6:7] offset:-1024 sc1
  s_and_b64 exec, s[48:49], s[48:49]
  s_cbranch_scc0 h_pl0
  global_load_dwordx4 v[112:115], v19, s[6:7] offset:0 sc1
h_pl0:
  s_mov_b64 exec, -1
  ds_write_b128 v3, v[48:51] offset:4096
  ds_write_b128 v3, v[52:55] offset:5120
  ds_write_b128 v3, v[56:59] offset:6144
  ds_write_b128 v3, v[60:63] offset:7168
  s_waitcnt lgkmcnt(0)
  s_barrier
  s_waitcnt vmcnt(0)
  v_bitop3_b32 v6, v96, v98, s8 bitop3:0x7e
  v_bitop3_b32 v30, v100, v102, s8 bitop3:0x7e
  v_bitop3_b32 v31, v104, v106, s8 bitop3:0x7e
  v_or3_b32 v6, v6, v30, v31
  v_bitop3_b32 v30, v108, v110, s8 bitop3:0x7e
  v_bitop3_b32 v31, v112, v114, s8 bitop3:0x7e
  v_bitop3_b32 v6, v6, v30, 1 bitop3:0xa8
  v_and_b32 v31, 1, v31
  v_cmp_ne_u32 vcc, 0, v6
  v_cmp_ne_u32 s[36:37], 0, v31
  s_and_b64 s[36:37], s[36:37], s[48:49]
  s_or_b64 vcc, vcc, s[36:37]
  s_cbranch_scc1 h_ly
  ds_write_b128 v3, v[96:99] offset:8192
  ds_write_b128 v3, v[100:103] offset:9216
  ds_write_b128 v3, v[104:107] offset:10240
  ds_write_b128 v3, v[108:111] offset:11264
  s_mov_b64 exec, s[48:49]
  ds_write_b128 v3, v[112:115] offset:12288
  s_branch h_lyd
h_ly:
  s_waitcnt vmcnt(0)
  s_mov_b64 exec, s[40:41]
  v_bitop3_b32 v6, v96, v98, s8 bitop3:0x7e
  v_and_b32 v6, 1, v6
  v_cmp_ne_u32 s[40:41], 0, v6
  s_andn2_b64 s[50:51], exec, s[40:41]
  s_and_b64 exec, s[40:41], s[40:41]
  s_cbranch_scc0 h_ls0
  global_load_dwordx4 v[96:99], v19, s[6:7] offset:-4096 sc1
h_ls0:
  s_mov_b64 exec, s[42:43]
  v_bitop3_b32 v6, v100, v102, s8 bitop3:0x7e
  v_and_b32 v6, 1, v6
  v_cmp_ne_u32 s[42:43], 0, v6
  s_andn2_b64 s[52:53], exec, s[42:43]
  s_and_b64 exec, s[42:43], s[42:43]
  s_cbranch_scc0 h_ls1
  global_load_dwordx4 v[100:103], v19, s[6:7] offset:-3072 sc1
h_ls1:
  s_mov_b64 exec, s[44:45]
  v_bitop3_b32 v6, v104, v106, s8 bitop3:0x7e
  v_and_b32 v6, 1, v6
  v_cmp_ne_u32 s[44:45], 0, v6
  s_andn2_b64 s[54:55], exec, s[44:45]
  s_and_b64 exec, s[44:45], s[44:45]
  s_cbranch_scc0 h_ls2
  global_load_dwordx4 v[104:107], v19, s[6:7] offset:-2048 sc1
h_ls2:
  s_mov_b64 exec, s[46:47]
  v_bitop3_b32 v6, v108, v110, s8 bitop3:0x7e
  v_and_b32 v6, 1, v6
  v_cmp_ne_u32 s[46:47], 0, v6
  s_andn2_b64 s[56:57], exec, s[46:47]
  s_and_b64 exec, s[46:47], s[46:47]
  s_cbranch_scc0 h_ls3
  global_load_dwordx4 v[108:111], v19, s[6:7] offset:-1024 sc1
h_ls3:
  s_mov_b64 exec, s[48:49]
  v_bitop3_b32 v6, v112, v114, s8 bitop3:0x7e
  v_and_b32 v6, 1, v6
  v_cmp_ne_u32 s[48:49], 0, v6
  s_andn2_b64 s[20:21], exec, s[48:49]
  s_and_b64 exec, s[48:49], s[48:49]
  s_cbranch_scc0 h_ls4
  global_load_dwordx4 v[112:115], v19, s[6:7] offset:0 sc1
h_ls4:
  s_mov_b64 exec, s[50:51]
  ds_write_b128 v3, v[96:99] offset:8192
  s_mov_b64 exec, s[52:53]
  ds_write_b128 v3, v[100:103] offset:9216
  s_mov_b64 exec, s[54:55]
  ds_write_b128 v3, v[104:107] offset:10240
  s_mov_b64 exec, s[56:57]
  ds_write_b128 v3, v[108:111] offset:11264
  s_mov_b64 exec, s[20:21]
  ds_write_b128 v3, v[112:115] offset:12288
  s_or_b64 s[36:37], s[40:41], s[42:43]
  s_or_b64 s[38:39], s[44:45], s[46:47]
  s_or_b64 s[36:37], s[36:37], s[48:49]
  s_or_b64 s[36:37], s[36:37], s[38:39]
  s_cbranch_scc0 h_lyd
  s_sub_u32 s58, s58, 1
  s_cbranch_scc0 h_ly
  buffer_wbl2 sc1
  s_mov_b32 s58, 31
  s_sub_u32 s30, s30, 1
  s_cbranch_scc0 h_ly
  s_mov_b32 s30, 0
h_lyd:
  s_mov_b64 exec, s[34:35]
  global_store_dwordx4 v18, v[20:23], s[28:29] sc1
  s_mov_b64 exec, -1
h_next:
  s_add_u32 s24, s24, 1
  s_add_u32 s28, s28, 3211264
  s_addc_u32 s29, s29, 0
  s_mov_b64 s[36:37], s[6:7]
  s_mov_b64 s[6:7], s[10:11]
  s_mov_b64 s[10:11], s[36:37]
  s_branch h_top
h_tok:
  s_cmp_lg_u32 s12, 15
  s_cbranch_scc1 h_tokd
  v_mov_b32 v6, 1
  s_lshl_b64 exec, 1, s9
  global_store_dword v17, v6, s[4:5] sc1
  s_mov_b64 exec, -1
  s_branch h_tokd
h_last:
  s_cmp_lg_u32 s12, 15
  s_cbranch_scc1 h_end
  s_mov_b32 s58, 31
  s_mov_b64 exec, 0xff
h_tp:
  global_load_dword v6, v17, s[4:5] sc1
  s_waitcnt vmcnt(0)
  v_cmp_eq_u32 vcc, 0, v6
  s_and_b64 exec, vcc, vcc
  s_cbranch_scc0 h_end
  s_sub_u32 s58, s58, 1
  s_cbranch_scc0 h_tp
  buffer_wbl2 sc1
  s_mov_b32 s58, 31
  s_sub_u32 s30, s30, 1
  s_cbranch_scc0 h_tp
  s_branch h_end
ga_ovf:
  s_lshl_b32 s36, s12, 10
  s_add_u32 s36, s36, 100352
  v_lshl_add_u32 v20, v1, 4, s36
  v_mov_b32 v24, 0
  v_mov_b32 v25, 0
  v_mov_b32 v26, 0
  v_mov_b32 v27, 0
  ds_write_b128 v20, v[24:27]
  s_lshl_b32 s37, s17, 2
  s_add_u32 s37, s37, 54846464
  v_lshl_add_u32 v21, v1, 2, s37
  s_mov_b32 s38, s18
ga_ol:
  v_cmp_gt_u32 vcc, s38, v1
  s_and_b64 exec, vcc, vcc
  global_load_dword v22, v21, s[4:5]
  s_waitcnt vmcnt(0)
  v_bfe_u32 v23, v22, 16, 15
  v_lshlrev_b32 v23, 3, v23
  ds_read_b64 v[24:25], v23
  v_bfe_u32 v22, v22, 6, 6
  v_lshl_add_u32 v22, v22, 4, s36
  s_waitcnt lgkmcnt(0)
  v_lshlrev_b32 v26, 16, v24
  v_and_b32 v27, 0xffff0000, v24
  v_lshlrev_b32 v30, 16, v25
  v_and_b32 v31, 0xffff0000, v25
  ds_add_f32 v22, v26
  ds_add_f32 v22, v27 offset:4
  ds_add_f32 v22, v30 offset:8
  ds_add_f32 v22, v31 offset:12
  s_mov_b64 exec, -1
  v_add_u32 v21, 256, v21
  s_waitcnt lgkmcnt(0)
  s_sub_u32 s38, s38, 64
  s_cbranch_scc1 ga_od
  s_cmp_lg_u32 s38, 0
  s_cbranch_scc1 ga_ol
ga_od:
  ds_read_b128 v[24:27], v20
  s_waitcnt lgkmcnt(0)
  v_add_f32 v12, v12, v24
  v_add_f32 v13, v13, v25
  v_add_f32 v14, v14, v26
  v_add_f32 v15, v15, v27
  s_branch ga_fin
gb_ovf:
  s_lshl_b32 s36, s12, 10
  s_add_u32 s36, s36, 100352
  v_lshl_add_u32 v20, v1, 4, s36
  v_mov_b32 v24, 0
  v_mov_b32 v25, 0
  v_mov_b32 v26, 0
  v_mov_b32 v27, 0
  ds_write_b128 v20, v[24:27]
  s_lshl_b32 s37, s21, 2
  s_add_u32 s37, s37, 54846464
  v_lshl_add_u32 v21, v1, 2, s37
  s_mov_b32 s38, s22
gb_ol:
  v_cmp_gt_u32 vcc, s38, v1
  s_and_b64 exec, vcc, vcc
  global_load_dword v22, v21, s[4:5]
  s_waitcnt vmcnt(0)
  v_bfe_u32 v23, v22, 16, 15
  v_lshlrev_b32 v23, 3, v23
  ds_read_b64 v[24:25], v23
  v_bfe_u32 v22, v22, 6, 6
  v_lshl_add_u32 v22, v22, 4, s36
  s_waitcnt lgkmcnt(0)
  v_lshlrev_b32 v26, 16, v24
  v_and_b32 v27, 0xffff0000, v24
  v_lshlrev_b32 v30, 16, v25
  v_and_b32 v31, 0xffff0000, v25
  ds_add_f32 v22, v26
  ds_add_f32 v22, v27 offset:4
  ds_add_f32 v22, v30 offset:8
  ds_add_f32 v22, v31 offset:12
  s_mov_b64 exec, -1
  v_add_u32 v21, 256, v21
  s_waitcnt lgkmcnt(0)
  s_sub_u32 s38, s38, 64
  s_cbranch_scc1 gb_od
  s_cmp_lg_u32 s38, 0
  s_cbranch_scc1 gb_ol
gb_od:
  ds_read_b128 v[24:27], v20
  s_waitcnt lgkmcnt(0)
  v_add_f32 v2, v2, v24
  v_add_f32 v3, v3, v25
  v_add_f32 v4, v4, v26
  v_add_f32 v5, v5, v27
  s_branch gb_fin
h_end:
  s_endpgm
.globl c_kernel
.p2align 8
.type c_kernel,@function
c_kernel:
  s_cmp_ge_u32 s2, 256
  s_cbranch_scc1 c_end
  s_load_dwordx2 s[4:5], s[0:1], 88
  s_load_dwordx2 s[6:7], s[0:1], 72
  v_lshrrev_b32 v10, 6, v0
  v_and_b32 v11, 63, v0
  v_readfirstlane_b32 s3, v10
  v_lshlrev_b32 v1, 4, v11
  v_and_b32 v12, 15, v11
  v_lshrrev_b32 v13, 4, v11
  v_and_b32 v14, 7, v11
  v_bfe_u32 v15, v11, 3, 1
  v_mul_u32_u24 v20, 3211264, v13
  v_mul_u32_u24 v16, 100352, v15
  v_xor_b32 v17, v14, v13
  v_lshlrev_b32 v17, 4, v17
  v_add3_u32 v20, v20, v16, v17
  v_xor_b32 v21, 64, v20
  v_add_u32 v21, 12844032, v21
  s_and_b32 s36, s3, 7
  s_mul_i32 s15, s2, 384
  s_mul_i32 s16, s36, 401408
  s_add_u32 s16, s16, s15
  s_lshl_b32 s32, s3, 12
  s_add_u32 s33, s32, 56446976
  v_add_u32 v16, s33, v1
  s_lshl_b32 s37, s36, 12
  s_add_u32 s37, s37, 81920
  v_mov_b32 v18, 151552
  v_mov_b32 v22, 0
  v_mov_b32 v23, 0
  v_mov_b32 v24, 0
  v_mov_b32 v25, 0
  s_cmp_ge_u32 s3, 8
  s_waitcnt lgkmcnt(0)
  s_cbranch_scc1 c_l0
  s_mov_b32 m0, s37
  s_add_u32 s16, s4, s16
  s_addc_u32 s17, s5, 0
  s_add_u32 s18, s16, 198656
  s_addc_u32 s19, s17, 0
  global_load_lds_dwordx4 v20, s[16:17] offset:0
  global_load_lds_dwordx4 v21, s[16:17] offset:1024
  global_load_lds_dwordx4 v20, s[18:19] offset:2048
  global_load_lds_dwordx4 v21, s[18:19] offset:3072
  s_cmp_ge_u32 s3, 4
  s_cbranch_scc1 c_nox
  s_lshl_b32 s34, s3, 10
  s_add_u32 s34, s34, 65536
  s_mov_b32 m0, s34
  s_add_u32 s34, s34, 56446976
  v_add_u32 v17, s34, v1
  global_load_lds_dwordx4 v17, s[4:5]
c_nox:
  s_mov_b32 m0, s32
  s_nop 0
  global_load_lds_dwordx4 v16, s[4:5]
  global_load_lds_dwordx4 v16, s[4:5] offset:1024
  global_load_lds_dwordx4 v16, s[4:5] offset:2048
  global_load_lds_dwordx4 v16, s[4:5] offset:3072
  s_barrier
  s_branch c_setup
c_l0:
  ds_write_b128 v18, v[22:25]
  s_mov_b32 m0, s32
  s_add_u32 s16, s4, s16
  s_addc_u32 s17, s5, 0
  s_add_u32 s18, s16, 198656
  s_addc_u32 s19, s17, 0
  s_add_u32 s34, s37, 32640
  s_waitcnt lgkmcnt(0)
  s_barrier
  global_load_lds_dwordx4 v16, s[4:5]
  global_load_lds_dwordx4 v16, s[4:5] offset:1024
  global_load_lds_dwordx4 v16, s[4:5] offset:2048
  global_load_lds_dwordx4 v16, s[4:5] offset:3072
  s_mov_b32 m0, s34
  s_nop 0
  global_load_lds_dwordx4 v20, s[16:17] offset:128
  global_load_lds_dwordx4 v21, s[16:17] offset:1152
  global_load_lds_dwordx4 v20, s[18:19] offset:2176
  global_load_lds_dwordx4 v21, s[18:19] offset:3200
c_setup:
  s_mov_b32 s33, 56520704
  s_load_dword s10, s[4:5], s33
  s_mul_i32 s15, s2, 24
  s_add_u32 s15, s15, s3
  s_cmp_lt_u32 s3, 8
  s_cselect_b32 s9, 8192, 0
  s_cselect_b32 s8, 1, 0
  s_cmp_lg_u32 s3, 8
  s_cbranch_scc1 c_nw8
  s_cmp_ge_u32 s2, 106
  s_cbranch_scc1 c_nw8
  s_add_u32 s34, s2, 6144
  s_sub_u32 s9, s34, s15
  s_lshl_b32 s9, s9, 9
c_nw8:
  s_setprio 3
  s_lshr_b32 s35, s3, 3
  s_lshl_b32 s35, s35, 15
  s_add_u32 s35, s35, 81920
  v_xor_b32 v16, s36, v14
  v_lshlrev_b32 v16, 4, v16
  v_lshl_add_u32 v16, v15, 3, v16
  v_lshl_add_u32 v16, v14, 8, v16
  v_and_b32 v17, 1, v13
  v_lshl_add_u32 v16, v17, 7, v16
  v_lshrrev_b32 v17, 5, v11
  v_lshl_add_u32 v16, v17, 11, v16
  v_add_u32 v7, s35, v16
  s_mov_b32 s20, 0xaaaaaaaa
  s_mov_b32 s21, 0xaaaaaaaa
  s_mov_b32 s22, 0xcccccccc
  s_mov_b32 s23, 0xcccccccc
  s_mov_b32 s24, 0x00f0000f
  s_mov_b32 s25, 0xf0000f00
  s_mov_b32 s12, 0x3c000000
  s_mov_b32 s13, 0x3fb8aa3b
  s_mov_b32 s14, 0x3727c5ac
  s_mul_i32 s32, s3, 768
  s_add_u32 s32, s32, 69632
  s_add_u32 s33, s32, 512
  v_add_u32 v2, 65536, v1
  v_lshl_add_u32 v3, v11, 2, s32
  v_lshl_add_u32 v4, v13, 4, s32
  v_lshl_add_u32 v0, v12, 2, s32
  v_lshrrev_b32 v16, 2, v11
  v_lshl_add_u32 v6, v16, 3, s33
  v_lshrrev_b32 v16, 5, v11
  v_xor_b32 v16, v16, v15
  v_cmp_eq_u32 vcc, 0, v16
  s_nop 1
  v_cndmask_b32 v9, 0, 1.0, vcc
  v_lshl_add_u32 v16, v16, 7, s33
  v_lshl_add_u32 v16, v12, 3, v16
  v_and_b32 v17, 1, v13
  v_lshl_add_u32 v5, v17, 2, v16
  s_lshl_b32 s15, s15, 9
  v_lshl_add_u32 v8, v11, 3, s15
  v_and_b32 v16, 1, v11
  v_lshlrev_b32 v16, 4, v16
  v_mov_b32 v17, 0x3f80
  v_lshlrev_b32 v16, v16, v17
  v_lshrrev_b32 v17, 1, v12
  v_lshlrev_b32 v18, 1, v13
  v_cmp_eq_u32 vcc, v17, v18
  s_nop 1
  v_cndmask_b32 v48, 0, v16, vcc
  v_add_u32 v18, 1, v18
  v_cmp_eq_u32 vcc, v17, v18
  s_nop 1
  v_cndmask_b32 v49, 0, v16, vcc
  v_mov_b32 v54, v48
  v_mov_b32 v55, v49
  v_mov_b32 v60, v48
  v_mov_b32 v61, v49
  v_mov_b32 v66, v48
  v_mov_b32 v67, v49
  v_mov_b32 v18, 151552
  v_mov_b32 v19, 1
  s_cmp_ge_u32 s3, 8
  s_cbranch_scc1 c_late
  s_mov_b64 exec, 1
  s_waitcnt vmcnt(0) lgkmcnt(0)
  ds_add_u32 v18, v19
  s_mov_b64 exec, -1
  s_mov_b32 s34, 0x100000
c_sp0:
  ds_read_b32 v17, v18 offset:0
  s_waitcnt lgkmcnt(0)
  v_readfirstlane_b32 s35, v17
  s_cmp_ge_u32 s35, 8
  s_cbranch_scc1 c_sp0_go
  s_sleep 1
  s_sub_u32 s34, s34, 1
  s_cmp_lg_u32 s34, 0
  s_cbranch_scc1 c_sp0
c_sp0_go:
  ds_read2st64_b64 v[22:25], v7 offset0:0 offset1:8
  ds_read2st64_b64 v[28:31], v7 offset0:16 offset1:24
  ds_read2st64_b64 v[34:37], v7 offset0:32 offset1:40
  ds_read2st64_b64 v[40:43], v7 offset0:48 offset1:56
  s_mov_b64 exec, 1
  s_waitcnt lgkmcnt(0)
  ds_add_u32 v18, v19 offset:4
  s_mov_b64 exec, -1
  s_branch c_body
c_late:
  s_cmp_ge_u32 s3, 12
  s_cbranch_scc1 c_l2
  s_waitcnt vmcnt(0) lgkmcnt(0)
  s_barrier
  s_branch c_loop
c_l2:
  s_sub_u32 s36, s3, 12
  s_lshl_b32 s34, s36, 13
  s_add_u32 s37, s34, 81664
  s_mov_b32 m0, s37
  s_sub_u32 s32, 4, s36
  s_mul_i32 s32, s32, 401408
  s_sub_u32 s16, s16, s32
  s_subb_u32 s17, s17, 0
  s_sub_u32 s18, s18, s32
  s_subb_u32 s19, s19, 0
  v_mul_u32_u24 v16, 3211264, v14
  v_lshrrev_b32 v17, 3, v11
  v_mul_u32_u24 v17, 100352, v17
  s_mul_i32 s32, s36, 802816
  s_lshl_b32 s33, s2, 4
  s_add_u32 s32, s32, s33
  s_add_u32 s32, s32, 98304
  v_add3_u32 v16, v16, v17, s32
  s_mov_b32 s34, 0x100000
c_sp1:
  ds_read_b32 v17, v18 offset:4
  s_waitcnt lgkmcnt(0)
  v_readfirstlane_b32 s35, v17
  s_cmp_ge_u32 s35, 8
  s_cbranch_scc1 c_sp1_go
  s_sleep 1
  s_sub_u32 s34, s34, 1
  s_cmp_lg_u32 s34, 0
  s_cbranch_scc1 c_sp1
c_sp1_go:
  global_load_lds_dwordx4 v20, s[16:17] offset:256
  global_load_lds_dwordx4 v21, s[16:17] offset:1280
  global_load_lds_dwordx4 v20, s[18:19] offset:2304
  global_load_lds_dwordx4 v21, s[18:19] offset:3328
  s_add_u32 s37, s37, 4096
  s_mov_b32 m0, s37
  s_add_u32 s16, s16, 401408
  s_addc_u32 s17, s17, 0
  s_add_u32 s18, s18, 401408
  s_addc_u32 s19, s19, 0
  s_waitcnt vmcnt(4)
  s_barrier
  global_load_lds_dwordx4 v20, s[16:17] offset:256
  global_load_lds_dwordx4 v21, s[16:17] offset:1280
  global_load_lds_dwordx4 v20, s[18:19] offset:2304
  global_load_lds_dwordx4 v21, s[18:19] offset:3328
  s_cmp_ge_u32 s2, 106
  s_cbranch_scc1 c_ns3
  s_lshl_b32 s34, s36, 10
  s_add_u32 s34, s34, 147456
  s_mov_b32 m0, s34
  s_nop 0
  global_load_lds_dwordx4 v16, s[4:5]
c_ns3:
  s_mov_b64 exec, 1
  s_waitcnt vmcnt(0)
  ds_add_u32 v18, v19 offset:8
  s_mov_b64 exec, -1
c_loop:
  ds_read2st64_b64 v[22:25], v7 offset0:0 offset1:8
  ds_read2st64_b64 v[28:31], v7 offset0:16 offset1:24
  ds_read2st64_b64 v[34:37], v7 offset0:32 offset1:40
  ds_read2st64_b64 v[40:43], v7 offset0:48 offset1:56
c_body:
  ds_read_b128 v[104:107], v2 offset:0
  ds_read_b128 v[108:111], v2 offset:1024
  ds_read_b128 v[112:115], v2 offset:2048
  ds_read_b128 v[116:119], v2 offset:3072
  ds_read_b128 v[120:123], v1 offset:0
  s_waitcnt lgkmcnt(5)
  v_mfma_f32_16x16x32_bf16 v[100:103], v[22:25], v[22:25], 0
  v_mfma_f32_16x16x32_bf16 v[100:103], v[28:31], v[28:31], v[100:103]
  v_mfma_f32_16x16x32_bf16 v[100:103], v[34:37], v[34:37], v[100:103]
  v_mfma_f32_16x16x32_bf16 v[100:103], v[40:43], v[40:43], v[100:103]
  ds_read_b128 v[124:127], v1 offset:1024
  s_waitcnt lgkmcnt(5)
  v_mfma_f32_16x16x32_bf16 v[10:13], v[104:107], v[22:25], 0
  ds_read_b128 v[104:107], v1 offset:2048
  s_waitcnt lgkmcnt(5)
  v_mfma_f32_16x16x32_bf16 v[10:13], v[108:111], v[28:31], v[10:13]
  ds_read_b128 v[108:111], v1 offset:3072
  s_waitcnt lgkmcnt(5)
  v_mfma_f32_16x16x32_bf16 v[10:13], v[112:115], v[34:37], v[10:13]
  v_cndmask_b32 v14, v100, v101, s[20:21]
  v_cndmask_b32 v15, v102, v103, s[20:21]
  ds_read_b128 v[112:115], v1 offset:4096
  s_waitcnt lgkmcnt(5)
  v_mfma_f32_16x16x32_bf16 v[10:13], v[116:119], v[40:43], v[10:13]
  v_cndmask_b32 v14, v14, v15, s[22:23]
  ds_read_b128 v[116:119], v1 offset:5120
  s_waitcnt lgkmcnt(5)
  v_mfma_f32_16x16x32_bf16 v[72:75], v[120:123], v[22:25], 0
  ds_read_b128 v[120:123], v1 offset:6144
  s_waitcnt lgkmcnt(5)
  v_mfma_f32_16x16x32_bf16 v[72:75], v[124:127], v[28:31], v[72:75]
  ds_read_b128 v[124:127], v1 offset:7168
  s_waitcnt lgkmcnt(5)
  v_mfma_f32_16x16x32_bf16 v[72:75], v[104:107], v[34:37], v[72:75]
  ds_read_b128 v[104:107], v1 offset:8192
  s_waitcnt lgkmcnt(5)
  v_mfma_f32_16x16x32_bf16 v[72:75], v[108:111], v[40:43], v[72:75]
  ds_read_b128 v[108:111], v1 offset:9216
  s_waitcnt lgkmcnt(5)
  v_mfma_f32_16x16x32_bf16 v[76:79], v[112:115], v[22:25], 0
  ds_write_b32 v3, v13
  v_fma_f32 v15, -v10, v10, s14
  v_fmac_f32 v15, s12, v14
  ds_read_b128 v[112:115], v1 offset:10240
  s_waitcnt lgkmcnt(6)
  v_mfma_f32_16x16x32_bf16 v[76:79], v[116:119], v[28:31], v[76:79]
  v_max_f32 v15, s14, v15
  v_rsq_f32 v15, v15
  ds_read_b128 v[116:119], v1 offset:11264
  s_waitcnt lgkmcnt(6)
  v_mfma_f32_16x16x32_bf16 v[76:79], v[120:123], v[34:37], v[76:79]
  s_mov_b64 exec, s[24:25]
  ds_write_b32 v0, v15 offset:256
  s_mov_b64 exec, -1
  v_cvt_pk_bf16_f32 v50, v72, v73
  v_cvt_pk_bf16_f32 v51, v74, v75
  ds_read_b128 v[120:123], v1 offset:12288
  s_waitcnt lgkmcnt(7)
  v_mfma_f32_16x16x32_bf16 v[76:79], v[124:127], v[40:43], v[76:79]
  ds_read_b128 v[124:127], v1 offset:13312
  s_waitcnt lgkmcnt(7)
  v_mfma_f32_16x16x32_bf16 v[80:83], v[104:107], v[22:25], 0
  ds_read_b128 v[104:107], v1 offset:14336
  s_waitcnt lgkmcnt(7)
  v_mfma_f32_16x16x32_bf16 v[80:83], v[108:111], v[28:31], v[80:83]
  ds_read_b128 v[108:111], v1 offset:15360
  s_waitcnt lgkmcnt(6)
  v_mfma_f32_16x16x32_bf16 v[80:83], v[112:115], v[34:37], v[80:83]
  v_cvt_pk_bf16_f32 v52, v76, v77
  v_cvt_pk_bf16_f32 v53, v78, v79
  ds_read_b128 v[112:115], v1 offset:16384
  s_waitcnt lgkmcnt(6)
  v_mfma_f32_16x16x32_bf16 v[80:83], v[116:119], v[40:43], v[80:83]
  v_mfma_f32_16x16x32_bf16 v[88:91], v[22:25], v[50:53], 0
  ds_read_b128 v[116:119], v1 offset:17408
  s_waitcnt lgkmcnt(5)
  v_mfma_f32_16x16x32_bf16 v[84:87], v[120:123], v[22:25], 0
  ds_read_b128 v[120:123], v1 offset:18432
  s_waitcnt lgkmcnt(5)
  v_mfma_f32_16x16x32_bf16 v[84:87], v[124:127], v[28:31], v[84:87]
  ds_read_b128 v[124:127], v1 offset:19456
  s_waitcnt lgkmcnt(5)
  v_mfma_f32_16x16x32_bf16 v[84:87], v[104:107], v[34:37], v[84:87]
  v_cvt_pk_bf16_f32 v56, v80, v81
  v_cvt_pk_bf16_f32 v57, v82, v83
  ds_read_b128 v[104:107], v1 offset:20480
  s_waitcnt lgkmcnt(5)
  v_mfma_f32_16x16x32_bf16 v[84:87], v[108:111], v[40:43], v[84:87]
  ds_read_b128 v[108:111], v1 offset:21504
  s_waitcnt lgkmcnt(5)
  v_mfma_f32_16x16x32_bf16 v[72:75], v[112:115], v[22:25], 0
  ds_read_b128 v[112:115], v1 offset:22528
  s_waitcnt lgkmcnt(5)
  v_mfma_f32_16x16x32_bf16 v[72:75], v[116:119], v[28:31], v[72:75]
  ds_read_b128 v[116:119], v1 offset:23552
  s_waitcnt lgkmcnt(5)
  v_mfma_f32_16x16x32_bf16 v[72:75], v[120:123], v[34:37], v[72:75]
  v_cvt_pk_bf16_f32 v58, v84, v85
  v_cvt_pk_bf16_f32 v59, v86, v87
  ds_read_b128 v[120:123], v1 offset:24576
  s_waitcnt lgkmcnt(5)
  v_mfma_f32_16x16x32_bf16 v[72:75], v[124:127], v[40:43], v[72:75]
  v_mfma_f32_16x16x32_bf16 v[88:91], v[28:31], v[56:59], v[88:91]
  s_cmp_lg_u32 s9, 0
  s_cbranch_scc1 c_pr_1
  s_setprio 2
c_pr_1:
  ds_read_b128 v[124:127], v1 offset:25600
  s_waitcnt lgkmcnt(5)
  v_mfma_f32_16x16x32_bf16 v[76:79], v[104:107], v[22:25], 0
  ds_read_b128 v[104:107], v1 offset:26624
  s_waitcnt lgkmcnt(5)
  v_mfma_f32_16x16x32_bf16 v[76:79], v[108:111], v[28:31], v[76:79]
  ds_read_b128 v[108:111], v1 offset:27648
  s_waitcnt lgkmcnt(5)
  v_mfma_f32_16x16x32_bf16 v[76:79], v[112:115], v[34:37], v[76:79]
  v_cvt_pk_bf16_f32 v62, v72, v73
  v_cvt_pk_bf16_f32 v63, v74, v75
  ds_read_b128 v[112:115], v1 offset:28672
  s_waitcnt lgkmcnt(5)
  v_mfma_f32_16x16x32_bf16 v[76:79], v[116:119], v[40:43], v[76:79]
  ds_read_b32 v10, v0 offset:256
  ds_read_b128 v[92:95], v4 offset:256
  ds_read_b128 v[96:99], v4
  ds_read_b128 v[100:103], v4 offset:64
  ds_read_b128 v[116:119], v1 offset:29696
  s_waitcnt lgkmcnt(9)
  v_mfma_f32_16x16x32_bf16 v[80:83], v[120:123], v[22:25], 0
  ds_read_b128 v[120:123], v1 offset:30720
  s_waitcnt lgkmcnt(9)
  v_mfma_f32_16x16x32_bf16 v[80:83], v[124:127], v[28:31], v[80:83]
  ds_read_b128 v[124:127], v1 offset:31744
  s_waitcnt lgkmcnt(9)
  v_mfma_f32_16x16x32_bf16 v[80:83], v[104:107], v[34:37], v[80:83]
  v_cvt_pk_bf16_f32 v64, v76, v77
  v_cvt_pk_bf16_f32 v65, v78, v79
  s_cmp_eq_u32 s8, 0
  s_cbranch_scc1 c_nob2
  s_barrier
c_nob2:
  ds_read_b128 v[104:107], v1 offset:32768
  s_waitcnt lgkmcnt(9)
  v_mfma_f32_16x16x32_bf16 v[80:83], v[108:111], v[40:43], v[80:83]
  v_mfma_f32_16x16x32_bf16 v[88:91], v[34:37], v[62:65], v[88:91]
  ds_read_b128 v[108:111], v1 offset:33792
  s_waitcnt lgkmcnt(9)
  v_mfma_f32_16x16x32_bf16 v[84:87], v[112:115], v[22:25], 0
  ds_read_b128 v[112:115], v1 offset:34816
  s_waitcnt lgkmcnt(5)
  v_mfma_f32_16x16x32_bf16 v[84:87], v[116:119], v[28:31], v[84:87]
  ds_read_b128 v[116:119], v1 offset:35840
  s_waitcnt lgkmcnt(5)
  v_mfma_f32_16x16x32_bf16 v[84:87], v[120:123], v[34:37], v[84:87]
  v_cvt_pk_bf16_f32 v68, v80, v81
  v_cvt_pk_bf16_f32 v69, v82, v83
  ds_read_b128 v[120:123], v1 offset:36864
  s_waitcnt lgkmcnt(5)
  v_mfma_f32_16x16x32_bf16 v[84:87], v[124:127], v[40:43], v[84:87]
  ds_read_b128 v[124:127], v1 offset:37888
  s_waitcnt lgkmcnt(5)
  v_mfma_f32_16x16x32_bf16 v[72:75], v[22:25], v[104:107], 0
  ds_read_b128 v[104:107], v1 offset:38912
  s_waitcnt lgkmcnt(5)
  v_mfma_f32_16x16x32_bf16 v[72:75], v[28:31], v[108:111], v[72:75]
  ds_read_b128 v[108:111], v1 offset:39936
  s_waitcnt lgkmcnt(5)
  v_mfma_f32_16x16x32_bf16 v[72:75], v[34:37], v[112:115], v[72:75]
  v_cvt_pk_bf16_f32 v70, v84, v85
  v_cvt_pk_bf16_f32 v71, v86, v87
  ds_read_b128 v[112:115], v1 offset:40960
  s_waitcnt lgkmcnt(5)
  v_mfma_f32_16x16x32_bf16 v[72:75], v[40:43], v[116:119], v[72:75]
  v_mfma_f32_16x16x32_bf16 v[88:91], v[40:43], v[68:71], v[88:91]
  ds_read_b128 v[116:119], v1 offset:41984
  s_waitcnt lgkmcnt(5)
  v_mfma_f32_16x16x32_bf16 v[76:79], v[22:25], v[120:123], 0
  ds_read_b128 v[120:123], v1 offset:43008
  s_waitcnt lgkmcnt(5)
  v_mfma_f32_16x16x32_bf16 v[76:79], v[28:31], v[124:127], v[76:79]
  ds_read_b128 v[124:127], v1 offset:44032
  s_waitcnt lgkmcnt(5)
  v_mfma_f32_16x16x32_bf16 v[76:79], v[34:37], v[104:107], v[76:79]
  v_cvt_pk_bf16_f32 v46, v72, v73
  v_cvt_pk_bf16_f32 v47, v74, v75
  v_mul_f32 v88, v88, v92
  v_mul_f32 v89, v89, v93
  v_mul_f32 v90, v90, v94
  ds_read_b128 v[104:107], v1 offset:45056
  s_waitcnt lgkmcnt(5)
  v_mfma_f32_16x16x32_bf16 v[76:79], v[40:43], v[108:111], v[76:79]
  v_mul_f32 v91, v91, v95
  v_max3_f32 v14, v88, v89, v90
  v_max_f32 v14, v14, v91
  v_mov_b32 v15, v14
  s_nop 1
  v_permlane16_swap_b32 v14, v15
  ds_read_b128 v[108:111], v1 offset:46080
  s_waitcnt lgkmcnt(5)
  v_mfma_f32_16x16x32_bf16 v[80:83], v[22:25], v[112:115], 0
  v_max_f32 v14, v14, v15
  v_mul_f32 v14, v14, v10
  v_fma_f32 v88, v88, v10, -v14
  v_fma_f32 v89, v89, v10, -v14
  v_fma_f32 v90, v90, v10, -v14
  ds_read_b128 v[112:115], v1 offset:47104
  s_waitcnt lgkmcnt(5)
  v_mfma_f32_16x16x32_bf16 v[80:83], v[28:31], v[116:119], v[80:83]
  v_fma_f32 v91, v91, v10, -v14
  v_exp_f32 v88, v88
  v_exp_f32 v89, v89
  v_exp_f32 v90, v90
  v_exp_f32 v91, v91
  ds_read_b128 v[116:119], v1 offset:48128
  s_waitcnt lgkmcnt(5)
  v_mfma_f32_16x16x32_bf16 v[80:83], v[34:37], v[120:123], v[80:83]
  v_add_f32 v14, v88, v89
  v_add_f32 v15, v90, v91
  v_add_f32 v14, v14, v15
  v_mul_f32 v88, v88, v92
  v_mov_b32 v15, v14
  ds_read_b128 v[120:123], v1 offset:49152
  s_waitcnt lgkmcnt(5)
  v_mfma_f32_16x16x32_bf16 v[80:83], v[40:43], v[124:127], v[80:83]
  v_mul_f32 v89, v89, v93
  v_mul_f32 v90, v90, v94
  v_permlane16_swap_b32 v14, v15
  v_add_f32 v14, v14, v15
  v_rcp_f32 v14, v14
  s_cmp_lg_u32 s9, 0
  s_cbranch_scc1 c_pr_2
  s_setprio 1
c_pr_2:
  ds_read_b128 v[124:127], v1 offset:50176
  s_waitcnt lgkmcnt(5)
  v_mfma_f32_16x16x32_bf16 v[84:87], v[22:25], v[104:107], 0
  v_mul_f32 v91, v91, v95
  v_mul_f32 v14, v14, v9
  v_mul_f32 v88, v88, v14
  v_mul_f32 v89, v89, v14
  v_mul_f32 v90, v90, v14
  ds_read_b128 v[104:107], v1 offset:51200
  s_waitcnt lgkmcnt(5)
  v_mfma_f32_16x16x32_bf16 v[84:87], v[28:31], v[108:111], v[84:87]
  v_mul_f32 v91, v91, v14
  v_cvt_pk_bf16_f32 v20, v88, v89
  v_cvt_pk_bf16_f32 v21, v90, v91
  v_cvt_pk_bf16_f32 v26, v88, v89
  v_cvt_pk_bf16_f32 v27, v90, v91
  ds_read_b128 v[108:111], v1 offset:52224
  s_waitcnt lgkmcnt(5)
  v_mfma_f32_16x16x32_bf16 v[84:87], v[34:37], v[112:115], v[84:87]
  v_cvt_pk_bf16_f32 v32, v88, v89
  v_cvt_pk_bf16_f32 v33, v90, v91
  v_cvt_pk_bf16_f32 v38, v88, v89
  v_cvt_pk_bf16_f32 v39, v90, v91
  v_cvt_pk_bf16_f32 v44, v88, v89
  ds_read_b128 v[112:115], v1 offset:53248
  s_waitcnt lgkmcnt(5)
  v_mfma_f32_16x16x32_bf16 v[84:87], v[40:43], v[116:119], v[84:87]
  v_cvt_pk_bf16_f32 v45, v90, v91
  v_fmac_f32 v11, v88, v96
  v_fmac_f32 v12, v88, v100
  v_fmac_f32 v11, v89, v97
  v_fmac_f32 v12, v89, v101
  v_fmac_f32 v11, v90, v98
  v_fmac_f32 v12, v90, v102
  v_fmac_f32 v11, v91, v99
  v_fmac_f32 v12, v91, v103
  s_nop 1
  v_permlane16_swap_b32 v11, v12
  v_add_f32 v11, v11, v12
  ds_write_b32 v5, v11
  v_cvt_pk_bf16_f32 v50, v76, v77
  v_cvt_pk_bf16_f32 v51, v78, v79
  v_cvt_pk_bf16_f32 v52, v80, v81
  v_cvt_pk_bf16_f32 v53, v82, v83
  ds_read_b128 v[116:119], v1 offset:54272
  s_waitcnt lgkmcnt(6)
  v_mfma_f32_16x16x32_bf16 v[72:75], v[22:25], v[120:123], 0
  ds_read_b128 v[120:123], v1 offset:55296
  s_waitcnt lgkmcnt(6)
  v_mfma_f32_16x16x32_bf16 v[72:75], v[28:31], v[124:127], v[72:75]
  ds_read_b128 v[124:127], v1 offset:56320
  s_waitcnt lgkmcnt(6)
  v_mfma_f32_16x16x32_bf16 v[72:75], v[34:37], v[104:107], v[72:75]
  v_cvt_pk_bf16_f32 v56, v84, v85
  v_cvt_pk_bf16_f32 v57, v86, v87
  ds_read_b128 v[104:107], v1 offset:57344
  s_waitcnt lgkmcnt(6)
  v_mfma_f32_16x16x32_bf16 v[72:75], v[40:43], v[108:111], v[72:75]
  v_mfma_f32_16x16x32_bf16 v[92:95], v[20:23], v[46:49], 0
  v_mfma_f32_16x16x32_bf16 v[88:91], v[24:27], v[48:51], 0
  ds_read_b64 v[10:11], v6
  ds_read_b128 v[108:111], v1 offset:58368
  s_waitcnt lgkmcnt(7)
  v_mfma_f32_16x16x32_bf16 v[76:79], v[22:25], v[112:115], 0
  ds_read_b128 v[112:115], v1 offset:59392
  s_waitcnt lgkmcnt(6)
  v_mfma_f32_16x16x32_bf16 v[76:79], v[28:31], v[116:119], v[76:79]
  ds_read_b128 v[116:119], v1 offset:60416
  s_waitcnt lgkmcnt(6)
  v_mfma_f32_16x16x32_bf16 v[76:79], v[34:37], v[120:123], v[76:79]
  v_cvt_pk_bf16_f32 v58, v72, v73
  v_cvt_pk_bf16_f32 v59, v74, v75
  ds_read_b128 v[120:123], v1 offset:61440
  s_waitcnt lgkmcnt(6)
  v_mfma_f32_16x16x32_bf16 v[76:79], v[40:43], v[124:127], v[76:79]
  v_mfma_f32_16x16x32_bf16 v[96:99], v[26:29], v[52:55], 0
  v_mfma_f32_16x16x32_bf16 v[100:103], v[30:33], v[54:57], 0
  v_mul_f32 v16, v92, v92
  v_mul_f32 v17, v93, v93
  v_mul_f32 v18, v94, v94
  v_mul_f32 v19, v95, v95
  v_fmac_f32 v16, v88, v88
  v_fmac_f32 v17, v89, v89
  v_fmac_f32 v18, v90, v90
  v_fmac_f32 v19, v91, v91
  ds_read_b128 v[124:127], v1 offset:62464
  s_waitcnt lgkmcnt(6)
  v_mfma_f32_16x16x32_bf16 v[80:83], v[22:25], v[104:107], 0
  ds_read_b128 v[104:107], v1 offset:63488
  s_waitcnt lgkmcnt(5)
  v_mfma_f32_16x16x32_bf16 v[80:83], v[28:31], v[108:111], v[80:83]
  ds_read_b128 v[108:111], v1 offset:64512
  s_waitcnt lgkmcnt(5)
  v_mfma_f32_16x16x32_bf16 v[80:83], v[34:37], v[112:115], v[80:83]
  v_cvt_pk_bf16_f32 v62, v76, v77
  v_cvt_pk_bf16_f32 v63, v78, v79
  s_waitcnt lgkmcnt(4)
  v_mfma_f32_16x16x32_bf16 v[80:83], v[40:43], v[116:119], v[80:83]
  v_mfma_f32_16x16x32_bf16 v[72:75], v[32:35], v[58:61], 0
  v_mfma_f32_16x16x32_bf16 v[76:79], v[36:39], v[60:63], 0
  v_fmac_f32 v16, v96, v96
  v_fmac_f32 v17, v97, v97
  v_fmac_f32 v18, v98, v98
  v_fmac_f32 v19, v99, v99
  v_fmac_f32 v16, v100, v100
  v_fmac_f32 v17, v101, v101
  v_fmac_f32 v18, v102, v102
  v_fmac_f32 v19, v103, v103
  s_waitcnt lgkmcnt(3)
  v_mfma_f32_16x16x32_bf16 v[84:87], v[22:25], v[120:123], 0
  s_waitcnt lgkmcnt(2)
  v_mfma_f32_16x16x32_bf16 v[84:87], v[28:31], v[124:127], v[84:87]
  s_waitcnt lgkmcnt(1)
  v_mfma_f32_16x16x32_bf16 v[84:87], v[34:37], v[104:107], v[84:87]
  v_cvt_pk_bf16_f32 v64, v80, v81
  v_cvt_pk_bf16_f32 v65, v82, v83
  s_waitcnt lgkmcnt(0)
  v_mfma_f32_16x16x32_bf16 v[84:87], v[40:43], v[108:111], v[84:87]
  v_mfma_f32_16x16x32_bf16 v[80:83], v[38:41], v[64:67], 0
  s_cmp_lg_u32 s9, 0
  s_cbranch_scc1 c_pr_3
  s_setprio 0
c_pr_3:
  v_fmac_f32 v16, v72, v72
  v_fmac_f32 v17, v73, v73
  v_fmac_f32 v18, v74, v74
  v_fmac_f32 v19, v75, v75
  s_nop 0
  v_cvt_pk_bf16_f32 v68, v84, v85
  v_cvt_pk_bf16_f32 v69, v86, v87
  v_fmac_f32 v16, v76, v76
  v_fmac_f32 v17, v77, v77
  v_mfma_f32_16x16x32_bf16 v[84:87], v[42:45], v[66:69], 0
  v_fmac_f32 v18, v78, v78
  v_fmac_f32 v19, v79, v79
  v_fmac_f32 v16, v80, v80
  v_fmac_f32 v17, v81, v81
  v_fmac_f32 v18, v82, v82
  v_fmac_f32 v19, v83, v83
  s_nop 1
  v_fmac_f32 v16, v84, v84
  v_fmac_f32 v17, v85, v85
  v_fmac_f32 v18, v86, v86
  v_fmac_f32 v19, v87, v87
  v_add_f32_dpp v16, v16, v16 row_ror:8 row_mask:0xf bank_mask:0x3
  v_add_f32_dpp v17, v17, v17 row_ror:8 row_mask:0xf bank_mask:0x3
  s_nop 0
  v_add_f32_dpp v16, v18, v18 row_ror:8 row_mask:0xf bank_mask:0xc
  v_add_f32_dpp v17, v19, v19 row_ror:8 row_mask:0xf bank_mask:0xc
  s_nop 0
  v_add_f32_dpp v16, v16, v16 row_shl:4 row_mask:0xf bank_mask:0x5
  s_nop 1
  v_add_f32_dpp v16, v17, v17 row_shr:4 row_mask:0xf bank_mask:0xa
  s_nop 1
  v_add_f32_dpp v16, v16, v16 quad_perm:[1,0,3,2] row_mask:0xf bank_mask:0xf
  s_nop 1
  v_add_f32_dpp v16, v16, v16 quad_perm:[2,3,0,1] row_mask:0xf bank_mask:0xf
  v_fma_f32 v17, -v10, s10, v11
  v_mul_f32 v16, s12, v16
  v_fma_f32 v16, -v10, v10, v16
  v_max_f32 v16, 0, v16
  v_add_f32 v16, s14, v16
  v_rsq_f32 v16, v16
  v_mul_f32 v17, s13, v17
  v_mul_f32 v17, v17, v16
  s_nop 1
  v_max_f32_dpp v16, v17, v17 row_ror:4 row_mask:0xf bank_mask:0xf
  s_nop 1
  v_max_f32_dpp v16, v16, v16 row_ror:8 row_mask:0xf bank_mask:0xf
  v_mov_b32 v18, v16
  s_nop 1
  v_permlane16_swap_b32 v16, v18
  v_max_f32 v16, v16, v18
  v_sub_f32 v17, v17, v16
  v_exp_f32 v17, v17
  s_nop 1
  v_add_f32_dpp v16, v17, v17 row_ror:4 row_mask:0xf bank_mask:0xf
  s_nop 1
  v_add_f32_dpp v16, v16, v16 row_ror:8 row_mask:0xf bank_mask:0xf
  v_mov_b32 v18, v16
  s_nop 1
  v_permlane16_swap_b32 v16, v18
  v_add_f32 v16, v16, v18
  v_rcp_f32 v16, v16
  s_nop 0
  v_mul_f32 v17, v17, v16
  s_nop 1
  v_mul_f32_dpp v104, v17, v92 row_newbcast:0 row_mask:0xf bank_mask:0xf
  v_mul_f32_dpp v105, v17, v88 row_newbcast:0 row_mask:0xf bank_mask:0xf
  v_mul_f32_dpp v106, v17, v96 row_newbcast:0 row_mask:0xf bank_mask:0xf
  v_mul_f32_dpp v107, v17, v100 row_newbcast:0 row_mask:0xf bank_mask:0xf
  v_mul_f32_dpp v108, v17, v72 row_newbcast:0 row_mask:0xf bank_mask:0xf
  v_mul_f32_dpp v109, v17, v76 row_newbcast:0 row_mask:0xf bank_mask:0xf
  v_mul_f32_dpp v110, v17, v80 row_newbcast:0 row_mask:0xf bank_mask:0xf
  v_mul_f32_dpp v111, v17, v84 row_newbcast:0 row_mask:0xf bank_mask:0xf
  v_fmac_f32_dpp v104, v17, v93 row_newbcast:4 row_mask:0xf bank_mask:0xf
  v_fmac_f32_dpp v105, v17, v89 row_newbcast:4 row_mask:0xf bank_mask:0xf
  v_fmac_f32_dpp v106, v17, v97 row_newbcast:4 row_mask:0xf bank_mask:0xf
  v_fmac_f32_dpp v107, v17, v101 row_newbcast:4 row_mask:0xf bank_mask:0xf
  v_fmac_f32_dpp v108, v17, v73 row_newbcast:4 row_mask:0xf bank_mask:0xf
  v_fmac_f32_dpp v109, v17, v77 row_newbcast:4 row_mask:0xf bank_mask:0xf
  v_fmac_f32_dpp v110, v17, v81 row_newbcast:4 row_mask:0xf bank_mask:0xf
  v_fmac_f32_dpp v111, v17, v85 row_newbcast:4 row_mask:0xf bank_mask:0xf
  v_fmac_f32_dpp v104, v17, v94 row_newbcast:8 row_mask:0xf bank_mask:0xf
  v_fmac_f32_dpp v105, v17, v90 row_newbcast:8 row_mask:0xf bank_mask:0xf
  v_fmac_f32_dpp v106, v17, v98 row_newbcast:8 row_mask:0xf bank_mask:0xf
  v_fmac_f32_dpp v107, v17, v102 row_newbcast:8 row_mask:0xf bank_mask:0xf
  v_fmac_f32_dpp v108, v17, v74 row_newbcast:8 row_mask:0xf bank_mask:0xf
  v_fmac_f32_dpp v109, v17, v78 row_newbcast:8 row_mask:0xf bank_mask:0xf
  v_fmac_f32_dpp v110, v17, v82 row_newbcast:8 row_mask:0xf bank_mask:0xf
  v_fmac_f32_dpp v111, v17, v86 row_newbcast:8 row_mask:0xf bank_mask:0xf
  v_fmac_f32_dpp v104, v17, v95 row_newbcast:12 row_mask:0xf bank_mask:0xf
  v_fmac_f32_dpp v105, v17, v91 row_newbcast:12 row_mask:0xf bank_mask:0xf
  v_fmac_f32_dpp v106, v17, v99 row_newbcast:12 row_mask:0xf bank_mask:0xf
  v_fmac_f32_dpp v107, v17, v103 row_newbcast:12 row_mask:0xf bank_mask:0xf
  v_fmac_f32_dpp v108, v17, v75 row_newbcast:12 row_mask:0xf bank_mask:0xf
  v_fmac_f32_dpp v109, v17, v79 row_newbcast:12 row_mask:0xf bank_mask:0xf
  v_fmac_f32_dpp v110, v17, v83 row_newbcast:12 row_mask:0xf bank_mask:0xf
  v_fmac_f32_dpp v111, v17, v87 row_newbcast:12 row_mask:0xf bank_mask:0xf
  v_permlane16_swap_b32 v104, v108
  v_permlane16_swap_b32 v105, v109
  v_permlane16_swap_b32 v106, v110
  v_permlane16_swap_b32 v107, v111
  v_add_f32 v104, v104, v108
  v_add_f32 v105, v105, v109
  v_add_f32 v106, v106, v110
  v_add_f32 v107, v107, v111
  v_cvt_pk_bf16_f32 v18, v104, v105
  v_cvt_pk_bf16_f32 v19, v106, v107
  global_store_dwordx2 v8, v[18:19], s[6:7]
  s_cmp_eq_u32 s9, 0
  s_cbranch_scc1 c_end
  v_add_u32 v8, s9, v8
  s_mov_b32 s9, 0
  s_mov_b32 s8, 0
  v_mov_b32 v14, 151552
  s_mov_b32 s34, 0x100000
c_sp2:
  ds_read_b32 v15, v14 offset:8
  s_waitcnt lgkmcnt(0)
  v_readfirstlane_b32 s35, v15
  s_cmp_ge_u32 s35, 4
  s_cbranch_scc1 c_sp2_go
  s_sleep 1
  s_sub_u32 s34, s34, 1
  s_cmp_lg_u32 s34, 0
  s_cbranch_scc1 c_sp2
c_sp2_go:
  s_cmp_lg_u32 s3, 8
  s_cbranch_scc1 c_loop
  v_and_b32 v14, 0x70, v1
  v_lshrrev_b32 v15, 8, v1
  v_lshl_add_u32 v14, v15, 7, v14
  v_bfe_u32 v15, v1, 7, 1
  v_lshl_add_u32 v14, v15, 3, v14
  v_add_u32 v14, 147456, v14
  ds_read2st64_b64 v[22:25], v14 offset0:0 offset1:1
  ds_read2st64_b64 v[28:31], v14 offset0:2 offset1:3
  ds_read2st64_b64 v[34:37], v14 offset0:4 offset1:5
  ds_read2st64_b64 v[40:43], v14 offset0:6 offset1:7
  s_branch c_body
c_end:
  s_endpgm
.section .rodata,"a"
.p2align 6
.amdhsa_kernel k1_kernel
  .amdhsa_next_free_vgpr 48
  .amdhsa_next_free_sgpr 102
  .amdhsa_accum_offset 44
  .amdhsa_group_segment_fixed_size 0
  .amdhsa_kernarg_size 96
  .amdhsa_user_sgpr_count 2
  .amdhsa_user_sgpr_kernarg_segment_ptr 1
  .amdhsa_system_sgpr_workgroup_id_x 1
.end_amdhsa_kernel
.p2align 6
.amdhsa_kernel k2_kernel
  .amdhsa_next_free_vgpr 120
  .amdhsa_next_free_sgpr 102
  .amdhsa_accum_offset 116
  .amdhsa_group_segment_fixed_size 0
  .amdhsa_kernarg_size 96
  .amdhsa_user_sgpr_count 2
  .amdhsa_user_sgpr_kernarg_segment_ptr 1
  .amdhsa_system_sgpr_workgroup_id_x 1
.end_amdhsa_kernel
.p2align 6
.amdhsa_kernel h_kernel
  .amdhsa_next_free_vgpr 128
  .amdhsa_next_free_sgpr 102
  .amdhsa_accum_offset 128
  .amdhsa_group_segment_fixed_size 0
  .amdhsa_kernarg_size 96
  .amdhsa_user_sgpr_count 2
  .amdhsa_user_sgpr_kernarg_segment_ptr 1
  .amdhsa_system_sgpr_workgroup_id_x 1
.end_amdhsa_kernel
.p2align 6
.amdhsa_kernel c_kernel
  .amdhsa_next_free_vgpr 128
  .amdhsa_next_free_sgpr 102
  .amdhsa_accum_offset 128
  .amdhsa_group_segment_fixed_size 0
  .amdhsa_kernarg_size 96
  .amdhsa_user_sgpr_count 2
  .amdhsa_user_sgpr_kernarg_segment_ptr 1
  .amdhsa_system_sgpr_workgroup_id_x 1
.end_amdhsa_kernel
```
